```python
import torch

def _softmax(x, axis=-1):
    return torch.softmax(x, dim=axis)
def _gelu(x):
    return torch.nn.functional.gelu(x, approximate="tanh")
def _silu(x):
    return torch.nn.functional.silu(x)
def _sigmoid(x):
    return torch.sigmoid(x)
def _layernorm(x, axis=-1, eps=1e-5):
    m = x.mean(dim=axis, keepdim=True)
    v = x.var(dim=axis, keepdim=True, unbiased=False)
    return (x - m) / torch.sqrt(v + eps)
def _scatter_add(tgt, idx, src, axis=0):
    return tgt.clone().index_add_(axis, idx, src)
def _segment_sum(src, seg, n):
    out = torch.zeros((n,) + src.shape[1:], dtype=src.dtype)
    return out.index_add_(0, seg, src)
def _pad(x, pw):
    flat = tuple(v for pair in reversed(pw) for v in pair)
    return torch.nn.functional.pad(x, flat)

kernel_name = 'standalone__kv_cache_quant_int4_int2_kv_with_per_channel_or_per_token_scales__sampling'

def setup_inputs():

    _w = (lambda a: (lambda t: t.to(torch.bfloat16) if t.is_floating_point() else t)(torch.as_tensor(a)))
    B = 8
    Sq = 4
    Skv = 2048
    Hq = 32
    Hkv = 16
    Dh = 128
    bits = 8
    G = 128
    if G <= 0 or G >= Skv:
        G = max(1, Skv // 2)
    Skv = (Skv // G) * G
    ngk = Skv // G
    qmax = (1 << bits) - 1
    return {
        "q": _w((lambda *s: torch.randn(*s, dtype=torch.bfloat16) * 0.4)(B, Hq, Sq, Dh)),
        "qk": _w(torch.randint(0, qmax + 1, (B, Hkv, Skv, Dh)).to(torch.int32)),
        "qv": _w(torch.randint(0, qmax + 1, (B, Hkv, Skv, Dh)).to(torch.int32)),
        "k_scales": _w(torch.abs((lambda *s: torch.randn(*s, dtype=torch.bfloat16) * 0.4)(B, Hkv, ngk, Dh)) * 0.05 + 0.02),
        "k_zeros": _w((lambda *s: torch.randn(*s, dtype=torch.bfloat16) * 0.4)(B, Hkv, ngk, Dh) + float(qmax) / 2.0),
        "v_scales": _w(torch.abs((lambda *s: torch.randn(*s, dtype=torch.bfloat16) * 0.05)(B, Hkv, Skv, 1)) * 0.05 + 0.02),
        "v_zeros": _w((lambda *s: torch.randn(*s, dtype=torch.bfloat16) * 0.05)(B, Hkv, Skv, 1) + float(qmax) / 2.0),
    }

def reference(q, qk, qv, k_scales, k_zeros, v_scales, v_zeros):
    B, Hq, Sq, Dh = q.shape
    Hkv, Skv = qk.shape[1], qk.shape[2]
    ngk = k_scales.shape[2]
    G = Skv // ngk
    ks = (lambda x, n, axis: torch.repeat_interleave(x, n, dim=axis))(k_scales, G, axis=2)
    kz = (lambda x, n, axis: torch.repeat_interleave(x, n, dim=axis))(k_zeros, G, axis=2)
    k = ((lambda x, dt: x.to(dt))(qk, q.dtype) - kz) * ks
    v = ((lambda x, dt: x.to(dt))(qv, q.dtype) - v_zeros) * v_scales
    rep = Hq // Hkv
    if rep > 1:
        k = (lambda x, n, axis: torch.repeat_interleave(x, n, dim=axis))(k, rep, axis=1)
        v = (lambda x, n, axis: torch.repeat_interleave(x, n, dim=axis))(v, rep, axis=1)
    scale = float(Dh) ** -0.5
    logits = torch.einsum("bhqd,bhkd->bhqk", q, k) * scale
    p = _softmax(logits, axis=-1)
    o = torch.einsum("bhqk,bhkd->bhqd", p, v)
    return o
```

```asm
; @launch grid=(256,1,1) block=(256,1,1) lds=90368
.amdgcn_target "amdgcn-amd-amdhsa--gfx950"
.text
.globl standalone__kv_cache_quant_int4_int2_kv_with_per_channel_or_per_token_scales__sampling_kernel
.p2align 8
.type standalone__kv_cache_quant_int4_int2_kv_with_per_channel_or_per_token_scales__sampling_kernel,@function
standalone__kv_cache_quant_int4_int2_kv_with_per_channel_or_per_token_scales__sampling_kernel:
  s_cmp_ge_u32 s2, 256
  s_cbranch_scc1 L_end
  s_load_dwordx16 s[4:19], s[0:1], 0
  s_load_dwordx4 s[20:23], s[0:1], 64
  v_lshrrev_b32 v6, 6, v0
  v_and_b32 v1, 63, v0
  s_lshr_b32 s49, s2, 1
  s_and_b32 s50, s2, 1
  v_readfirstlane_b32 s48, v6
  v_and_b32 v7, 15, v1
  v_lshrrev_b32 v8, 4, v1
  v_lshrrev_b32 v9, 2, v7
  v_lshlrev_b32 v2, 12, v9
  v_bfe_u32 v9, v7, 1, 1
  v_lshl_add_u32 v2, v9, 9, v2
  v_and_b32 v9, 1, v7
  v_lshl_add_u32 v2, v9, 6, v2
  v_lshl_add_u32 v2, v8, 4, v2
  v_lshlrev_b32 v10, 5, v9
  v_lshl_add_u32 v10, v8, 3, v10
  v_lshrrev_b32 v9, 3, v7
  v_lshlrev_b32 v11, 5, v9
  v_lshl_add_u32 v11, v8, 3, v11
  v_and_b32 v9, 7, v7
  v_lshl_add_u32 v12, v9, 8, v11
  v_lshlrev_b32 v3, 12, v8
  v_lshl_add_u32 v3, v7, 4, v3
  v_lshl_add_u32 v4, v8, 2, v6
  v_lshlrev_b32 v4, 2, v4
  v_add_u32 v4, 5120, v4
  v_lshlrev_b32 v5, 4, v1
  v_lshlrev_b32 v9, 9, v8
  v_lshl_add_u32 v9, v7, 4, v9
  s_mov_b32 s44, 0x00ff00ff
  s_mov_b32 s45, 0x00ff00ff
  s_mov_b32 s46, 0x3e0293ee
  s_mov_b32 s47, 0xbe0293ee
  s_lshl_b32 s51, s49, 20
  s_lshl_b32 s55, s50, 16
  s_add_u32 s51, s51, s55
  s_lshl_b32 s55, s48, 10
  s_add_u32 s51, s51, s55
  s_bfe_u32 s54, s2, 0x30003
  s_lshl_b32 s76, s54, 17
  s_add_u32 s76, s76, s51
  s_add_u32 s77, s76, 16384
  s_add_u32 s78, s76, 32768
  s_add_u32 s79, s76, 49152
  s_mul_i32 s60, s54, 5632
  s_lshl_b32 s55, s49, 12
  s_lshl_b32 s56, s50, 8
  s_add_u32 s55, s55, s56
  s_lshl_b32 s56, s49, 11
  s_cmp_lg_u32 s48, 0
  s_cselect_b32 s56, 0x40000, s56
  s_waitcnt lgkmcnt(0)
  s_cmp_eq_u32 s48, 1
  s_cselect_b32 s40, s10, s16
  s_cselect_b32 s41, s11, s17
  s_cmp_eq_u32 s48, 2
  s_cselect_b32 s40, s12, s40
  s_cselect_b32 s41, s13, s41
  s_cmp_eq_u32 s48, 3
  s_cselect_b32 s40, s14, s40
  s_cselect_b32 s41, s15, s41
  s_and_b32 s41, s41, 0xffff
  s_mov_b32 s42, 524288
  s_mov_b32 s43, 0x20000
  buffer_load_dwordx4 v[36:39], v9, s[40:43], s55 offen
  buffer_load_dwordx4 v[40:43], v9, s[40:43], s55 offen offset:2048
  s_mov_b32 s64, s4
  s_and_b32 s65, s5, 0xffff
  s_mov_b32 s66, 262144
  s_mov_b32 s67, 0x20000
  buffer_load_dwordx4 v[44:47], v5, s[64:67], s56 offen
  buffer_load_dwordx4 v[48:51], v5, s[64:67], s56 offen offset:1024
  s_mov_b32 s24, s6
  s_and_b32 s25, s7, 0xffff
  s_mov_b32 s26, 134217728
  s_mov_b32 s27, 0x20000
  buffer_load_dwordx4 v[124:127], v2, s[24:27], s76 offen offset:0 nt
  buffer_load_dwordx4 v[128:131], v2, s[24:27], s76 offen offset:128 nt
  buffer_load_dwordx4 v[132:135], v2, s[24:27], s76 offen offset:256 nt
  buffer_load_dwordx4 v[136:139], v2, s[24:27], s76 offen offset:384 nt
  buffer_load_dwordx4 v[140:143], v2, s[24:27], s77 offen offset:0 nt
  buffer_load_dwordx4 v[144:147], v2, s[24:27], s77 offen offset:128 nt
  buffer_load_dwordx4 v[148:151], v2, s[24:27], s77 offen offset:256 nt
  buffer_load_dwordx4 v[152:155], v2, s[24:27], s77 offen offset:384 nt
  buffer_load_dwordx4 v[156:159], v2, s[24:27], s78 offen offset:0 nt
  buffer_load_dwordx4 v[160:163], v2, s[24:27], s78 offen offset:128 nt
  buffer_load_dwordx4 v[164:167], v2, s[24:27], s78 offen offset:256 nt
  buffer_load_dwordx4 v[168:171], v2, s[24:27], s78 offen offset:384 nt
  buffer_load_dwordx4 v[172:175], v2, s[24:27], s79 offen offset:0 nt
  buffer_load_dwordx4 v[176:179], v2, s[24:27], s79 offen offset:128 nt
  buffer_load_dwordx4 v[180:183], v2, s[24:27], s79 offen offset:256 nt
  buffer_load_dwordx4 v[184:187], v2, s[24:27], s79 offen offset:384 nt
  s_mov_b32 s53, s60
  s_lshl_b32 s52, s54, 10
  s_add_u32 s54, s54, 1
  s_and_b32 s54, s54, 7
  s_lshl_b32 s76, s54, 17
  s_add_u32 s76, s76, s51
  s_add_u32 s77, s76, 16384
  s_add_u32 s78, s76, 32768
  s_add_u32 s79, s76, 49152
  s_mul_i32 s60, s54, 5632
  s_mov_b32 s28, s8
  s_and_b32 s29, s9, 0xffff
  s_mov_b32 s30, 134217728
  s_mov_b32 s31, 0x20000
  v_mov_b32 v80, 0
  v_mov_b32 v81, 0
  v_mov_b32 v82, 0
  v_mov_b32 v83, 0
  v_mov_b32 v84, 0
  v_mov_b32 v85, 0
  v_mov_b32 v86, 0
  v_mov_b32 v87, 0
  v_mov_b32 v88, 0
  v_mov_b32 v89, 0
  v_mov_b32 v90, 0
  v_mov_b32 v91, 0
  v_mov_b32 v92, 0
  v_mov_b32 v93, 0
  v_mov_b32 v94, 0
  v_mov_b32 v95, 0
  v_mov_b32 v96, 0
  v_mov_b32 v97, 0
  v_mov_b32 v98, 0
  v_mov_b32 v99, 0
  v_mov_b32 v100, 0
  v_mov_b32 v101, 0
  v_mov_b32 v102, 0
  v_mov_b32 v103, 0
  v_mov_b32 v104, 0
  v_mov_b32 v105, 0
  v_mov_b32 v106, 0
  v_mov_b32 v107, 0
  v_mov_b32 v108, 0
  v_mov_b32 v109, 0
  v_mov_b32 v110, 0
  v_mov_b32 v111, 0
  v_mov_b32 v112, 0
  v_mov_b32 v113, 0
  v_mov_b32 v114, 0
  v_mov_b32 v115, 0
  v_mov_b32 v14, 0xff800000
  v_mov_b32 v15, 0
  s_add_u32 s57, s48, 1
  s_and_b32 s57, s57, 2
  s_mov_b32 s55, 5632
  s_cmp_lg_u32 s57, 0
  s_cselect_b32 s55, 256, s55
  s_lshl_b32 s56, s48, 11
  s_add_u32 s56, s56, 45056
  s_cmp_eq_u32 s48, 3
  s_cselect_b32 s56, 5120, s56
  s_cmp_eq_u32 s48, 0
  s_cselect_b32 s56, 5376, s56
  v_mul_lo_u32 v9, v8, s55
  v_lshl_add_u32 v9, v7, 4, v9
  v_add_u32 v9, s56, v9
  s_lshl_b32 s55, s55, 2
  v_add_u32 v13, s55, v9
  v_mov_b32 v52, 0
  v_mov_b32 v53, 0
  ds_write_b64 v52, v[52:53] offset:57536
  s_waitcnt vmcnt(18)
  ds_write_b128 v9, v[36:39]
  ds_write_b128 v13, v[40:43]
  s_waitcnt vmcnt(16)
  s_cmp_lg_u32 s48, 0
  s_cbranch_scc1 L_noq
  ds_write_b128 v5, v[44:47] offset:45056
  ds_write_b128 v5, v[48:51] offset:46080
L_noq:
  s_waitcnt lgkmcnt(0)
  s_barrier
  ds_read_b64 v[16:17], v12 offset:45056
  ds_read_b64 v[18:19], v12 offset:45120
  ds_read_b64 v[20:21], v12 offset:45184
  ds_read_b64 v[22:23], v12 offset:45248
  s_lshl_b32 s55, s48, 9
  v_add_u32 v11, s55, v11
  v_add_u32 v10, s55, v10
  ds_read_b64 v[48:49], v11 offset:47104
  ds_read_b64 v[50:51], v11 offset:47168
  ds_read_b64 v[52:53], v11 offset:47232
  ds_read_b64 v[54:55], v11 offset:47296
  ds_read_b64 v[56:57], v10 offset:49152
  ds_read_b64 v[58:59], v10 offset:49216
  ds_read_b64 v[60:61], v10 offset:49280
  ds_read_b64 v[62:63], v10 offset:49344
  ds_read_b64 v[64:65], v11 offset:47360
  ds_read_b64 v[66:67], v11 offset:47424
  ds_read_b64 v[68:69], v11 offset:47488
  ds_read_b64 v[70:71], v11 offset:47552
  ds_read_b64 v[72:73], v10 offset:49408
  ds_read_b64 v[74:75], v10 offset:49472
  ds_read_b64 v[76:77], v10 offset:49536
  ds_read_b64 v[78:79], v10 offset:49600
  s_mul_i32 s57, s48, 11264
  v_add_u32 v13, s57, v5
  s_waitcnt lgkmcnt(0)
  v_lshlrev_b32 v116, 16, v16
  v_and_b32 v117, 0xffff0000, v16
  v_lshlrev_b32 v118, 16, v17
  v_and_b32 v119, 0xffff0000, v17
  v_lshlrev_b32 v120, 16, v18
  v_and_b32 v121, 0xffff0000, v18
  v_lshlrev_b32 v122, 16, v19
  v_and_b32 v123, 0xffff0000, v19
  v_lshlrev_b32 v252, 16, v20
  v_and_b32 v253, 0xffff0000, v20
  v_lshlrev_b32 v254, 16, v21
  v_and_b32 v255, 0xffff0000, v21
  v_lshlrev_b32 v44, 16, v22
  v_and_b32 v45, 0xffff0000, v22
  v_lshlrev_b32 v46, 16, v23
  v_and_b32 v47, 0xffff0000, v23
  v_lshlrev_b32 v6, 16, v48
  v_and_b32 v7, 0xffff0000, v48
  v_mul_f32 v6, v6, v116
  v_mul_f32 v7, v7, v117
  v_cvt_pk_bf16_f32 v16, v6, v7
  v_lshlrev_b32 v8, 16, v16
  v_and_b32 v9, 0xffff0000, v16
  v_sub_f32 v6, v6, v8
  buffer_load_dwordx4 v[188:191], v2, s[24:27], s76 offen offset:0 nt
  v_sub_f32 v7, v7, v9
  v_cvt_pk_bf16_f32 v24, v6, v7
  v_lshlrev_b32 v6, 16, v49
  v_and_b32 v7, 0xffff0000, v49
  v_mul_f32 v6, v6, v118
  v_mul_f32 v7, v7, v119
  v_cvt_pk_bf16_f32 v17, v6, v7
  v_lshlrev_b32 v8, 16, v17
  v_and_b32 v9, 0xffff0000, v17
  v_sub_f32 v6, v6, v8
  v_sub_f32 v7, v7, v9
  v_cvt_pk_bf16_f32 v25, v6, v7
  v_lshlrev_b32 v6, 16, v50
  v_and_b32 v7, 0xffff0000, v50
  v_mul_f32 v6, v6, v120
  v_mul_f32 v7, v7, v121
  v_cvt_pk_bf16_f32 v18, v6, v7
  v_lshlrev_b32 v8, 16, v18
  v_and_b32 v9, 0xffff0000, v18
  v_sub_f32 v6, v6, v8
  v_sub_f32 v7, v7, v9
  v_cvt_pk_bf16_f32 v26, v6, v7
  v_lshlrev_b32 v6, 16, v51
  v_and_b32 v7, 0xffff0000, v51
  buffer_load_dwordx4 v[192:195], v2, s[24:27], s76 offen offset:128 nt
  v_mul_f32 v6, v6, v122
  v_mul_f32 v7, v7, v123
  v_cvt_pk_bf16_f32 v19, v6, v7
  v_lshlrev_b32 v8, 16, v19
  v_and_b32 v9, 0xffff0000, v19
  v_sub_f32 v6, v6, v8
  v_sub_f32 v7, v7, v9
  v_cvt_pk_bf16_f32 v27, v6, v7
  v_lshlrev_b32 v6, 16, v52
  v_and_b32 v7, 0xffff0000, v52
  v_mul_f32 v6, v6, v252
  v_mul_f32 v7, v7, v253
  v_cvt_pk_bf16_f32 v20, v6, v7
  v_lshlrev_b32 v8, 16, v20
  v_and_b32 v9, 0xffff0000, v20
  v_sub_f32 v6, v6, v8
  v_sub_f32 v7, v7, v9
  v_cvt_pk_bf16_f32 v28, v6, v7
  v_lshlrev_b32 v6, 16, v53
  v_and_b32 v7, 0xffff0000, v53
  v_mul_f32 v6, v6, v254
  v_mul_f32 v7, v7, v255
  v_cvt_pk_bf16_f32 v21, v6, v7
  v_lshlrev_b32 v8, 16, v21
  buffer_load_dwordx4 v[196:199], v2, s[24:27], s76 offen offset:256 nt
  v_and_b32 v9, 0xffff0000, v21
  v_sub_f32 v6, v6, v8
  v_sub_f32 v7, v7, v9
  v_cvt_pk_bf16_f32 v29, v6, v7
  v_lshlrev_b32 v6, 16, v54
  v_and_b32 v7, 0xffff0000, v54
  v_mul_f32 v6, v6, v44
  v_mul_f32 v7, v7, v45
  v_cvt_pk_bf16_f32 v22, v6, v7
  v_lshlrev_b32 v8, 16, v22
  v_and_b32 v9, 0xffff0000, v22
  v_sub_f32 v6, v6, v8
  v_sub_f32 v7, v7, v9
  v_cvt_pk_bf16_f32 v30, v6, v7
  v_lshlrev_b32 v6, 16, v55
  v_and_b32 v7, 0xffff0000, v55
  v_mul_f32 v6, v6, v46
  v_mul_f32 v7, v7, v47
  v_cvt_pk_bf16_f32 v23, v6, v7
  v_lshlrev_b32 v8, 16, v23
  v_and_b32 v9, 0xffff0000, v23
  v_sub_f32 v6, v6, v8
  v_sub_f32 v7, v7, v9
  v_cvt_pk_bf16_f32 v31, v6, v7
  buffer_load_dwordx4 v[200:203], v2, s[24:27], s76 offen offset:384 nt
  v_xor_b32 v56, 0x80008000, v56
  v_xor_b32 v57, 0x80008000, v57
  v_xor_b32 v58, 0x80008000, v58
  v_xor_b32 v59, 0x80008000, v59
  v_xor_b32 v60, 0x80008000, v60
  v_xor_b32 v61, 0x80008000, v61
  v_xor_b32 v62, 0x80008000, v62
  v_xor_b32 v63, 0x80008000, v63
  s_nop 1
  v_mfma_f32_16x16x32_bf16 v[32:35], v[56:59], v[16:19], 0
  v_mfma_f32_16x16x32_bf16 v[32:35], v[60:63], v[20:23], v[32:35]
  v_mfma_f32_16x16x32_bf16 v[32:35], v[56:59], v[24:27], v[32:35]
  v_mfma_f32_16x16x32_bf16 v[32:35], v[60:63], v[28:31], v[32:35]
  ds_write_b128 v13, v[16:19] offset:0
  ds_write_b128 v13, v[20:23] offset:1024
  ds_write_b128 v13, v[24:27] offset:2048
  ds_write_b128 v13, v[28:31] offset:3072
  s_nop 7
  ds_write_b128 v13, v[32:35] offset:4096
  s_waitcnt lgkmcnt(0)
  v_lshlrev_b32 v6, 16, v64
  v_and_b32 v7, 0xffff0000, v64
  v_mul_f32 v6, v6, v116
  v_mul_f32 v7, v7, v117
  v_cvt_pk_bf16_f32 v16, v6, v7
  v_lshlrev_b32 v8, 16, v16
  v_and_b32 v9, 0xffff0000, v16
  v_sub_f32 v6, v6, v8
  v_sub_f32 v7, v7, v9
  v_cvt_pk_bf16_f32 v24, v6, v7
  v_lshlrev_b32 v6, 16, v65
  v_and_b32 v7, 0xffff0000, v65
  v_mul_f32 v6, v6, v118
  v_mul_f32 v7, v7, v119
  v_cvt_pk_bf16_f32 v17, v6, v7
  v_lshlrev_b32 v8, 16, v17
  buffer_load_dwordx4 v[204:207], v2, s[24:27], s77 offen offset:0 nt
  v_and_b32 v9, 0xffff0000, v17
  v_sub_f32 v6, v6, v8
  v_sub_f32 v7, v7, v9
  v_cvt_pk_bf16_f32 v25, v6, v7
  v_lshlrev_b32 v6, 16, v66
  v_and_b32 v7, 0xffff0000, v66
  v_mul_f32 v6, v6, v120
  v_mul_f32 v7, v7, v121
  v_cvt_pk_bf16_f32 v18, v6, v7
  v_lshlrev_b32 v8, 16, v18
  v_and_b32 v9, 0xffff0000, v18
  v_sub_f32 v6, v6, v8
  v_sub_f32 v7, v7, v9
  v_cvt_pk_bf16_f32 v26, v6, v7
  v_lshlrev_b32 v6, 16, v67
  v_and_b32 v7, 0xffff0000, v67
  v_mul_f32 v6, v6, v122
  v_mul_f32 v7, v7, v123
  v_cvt_pk_bf16_f32 v19, v6, v7
  v_lshlrev_b32 v8, 16, v19
  v_and_b32 v9, 0xffff0000, v19
  v_sub_f32 v6, v6, v8
  v_sub_f32 v7, v7, v9
  v_cvt_pk_bf16_f32 v27, v6, v7
  buffer_load_dwordx4 v[208:211], v2, s[24:27], s77 offen offset:128 nt
  v_lshlrev_b32 v6, 16, v68
  v_and_b32 v7, 0xffff0000, v68
  v_mul_f32 v6, v6, v252
  v_mul_f32 v7, v7, v253
  v_cvt_pk_bf16_f32 v20, v6, v7
  v_lshlrev_b32 v8, 16, v20
  v_and_b32 v9, 0xffff0000, v20
  v_sub_f32 v6, v6, v8
  v_sub_f32 v7, v7, v9
  v_cvt_pk_bf16_f32 v28, v6, v7
  v_lshlrev_b32 v6, 16, v69
  v_and_b32 v7, 0xffff0000, v69
  v_mul_f32 v6, v6, v254
  v_mul_f32 v7, v7, v255
  v_cvt_pk_bf16_f32 v21, v6, v7
  v_lshlrev_b32 v8, 16, v21
  v_and_b32 v9, 0xffff0000, v21
  v_sub_f32 v6, v6, v8
  v_sub_f32 v7, v7, v9
  v_cvt_pk_bf16_f32 v29, v6, v7
  v_lshlrev_b32 v6, 16, v70
  v_and_b32 v7, 0xffff0000, v70
  v_mul_f32 v6, v6, v44
  v_mul_f32 v7, v7, v45
  buffer_load_dwordx4 v[212:215], v2, s[24:27], s77 offen offset:256 nt
  v_cvt_pk_bf16_f32 v22, v6, v7
  v_lshlrev_b32 v8, 16, v22
  v_and_b32 v9, 0xffff0000, v22
  v_sub_f32 v6, v6, v8
  v_sub_f32 v7, v7, v9
  v_cvt_pk_bf16_f32 v30, v6, v7
  v_lshlrev_b32 v6, 16, v71
  v_and_b32 v7, 0xffff0000, v71
  v_mul_f32 v6, v6, v46
  v_mul_f32 v7, v7, v47
  v_cvt_pk_bf16_f32 v23, v6, v7
  v_lshlrev_b32 v8, 16, v23
  v_and_b32 v9, 0xffff0000, v23
  v_sub_f32 v6, v6, v8
  v_sub_f32 v7, v7, v9
  v_cvt_pk_bf16_f32 v31, v6, v7
  v_xor_b32 v72, 0x80008000, v72
  v_xor_b32 v73, 0x80008000, v73
  v_xor_b32 v74, 0x80008000, v74
  v_xor_b32 v75, 0x80008000, v75
  v_xor_b32 v76, 0x80008000, v76
  v_xor_b32 v77, 0x80008000, v77
  v_xor_b32 v78, 0x80008000, v78
  v_xor_b32 v79, 0x80008000, v79
  buffer_load_dwordx4 v[216:219], v2, s[24:27], s77 offen offset:384 nt
  s_nop 1
  v_mfma_f32_16x16x32_bf16 v[32:35], v[72:75], v[16:19], 0
  v_mfma_f32_16x16x32_bf16 v[32:35], v[76:79], v[20:23], v[32:35]
  v_mfma_f32_16x16x32_bf16 v[32:35], v[72:75], v[24:27], v[32:35]
  v_mfma_f32_16x16x32_bf16 v[32:35], v[76:79], v[28:31], v[32:35]
  ds_write_b128 v13, v[16:19] offset:5632
  ds_write_b128 v13, v[20:23] offset:6656
  ds_write_b128 v13, v[24:27] offset:7680
  ds_write_b128 v13, v[28:31] offset:8704
  s_nop 7
  ds_write_b128 v13, v[32:35] offset:9728
  s_waitcnt lgkmcnt(0)
  s_barrier
  v_add_u32 v6, s53, v5
  ds_read_b128 v[16:19], v6 offset:0
  ds_read_b128 v[20:23], v6 offset:1024
  ds_read_b128 v[24:27], v6 offset:2048
  ds_read_b128 v[28:31], v6 offset:3072
  ds_read_b128 v[32:35], v6 offset:4096
  v_and_b32 v7, 7, v1
  v_lshrrev_b32 v8, 4, v1
  v_lshl_add_u32 v7, v8, 3, v7
  v_lshlrev_b32 v254, 5, v7
  s_lshl_b32 s55, s48, 13
  s_add_u32 s55, s55, 57600
  v_add_u32 v254, s55, v254
  s_waitcnt vmcnt(20) lgkmcnt(0)
  v_cvt_f32_i32 v124, v124
  v_cvt_f32_i32 v125, v125
  v_cvt_f32_i32 v126, v126
  v_cvt_f32_i32 v127, v127
  v_cvt_f32_i32 v128, v128
  v_cvt_f32_i32 v129, v129
  v_cvt_f32_i32 v130, v130
  s_waitcnt vmcnt(4)
  buffer_load_dwordx4 v[220:223], v2, s[24:27], s78 offen offset:0 nt
  v_cvt_f32_i32 v131, v131
  v_cvt_f32_i32 v132, v132
  v_cvt_f32_i32 v133, v133
  v_cvt_f32_i32 v134, v134
  v_cvt_f32_i32 v135, v135
  v_cvt_f32_i32 v136, v136
  v_cvt_f32_i32 v137, v137
  v_cvt_f32_i32 v138, v138
  s_waitcnt vmcnt(4)
  buffer_load_dwordx4 v[224:227], v2, s[24:27], s78 offen offset:128 nt
  v_cvt_f32_i32 v139, v139
  v_cvt_pk_bf16_f32 v124, v124, v125
  v_cvt_pk_bf16_f32 v125, v126, v127
  v_cvt_pk_bf16_f32 v126, v128, v129
  v_cvt_pk_bf16_f32 v127, v130, v131
  v_cvt_pk_bf16_f32 v132, v132, v133
  v_cvt_pk_bf16_f32 v133, v134, v135
  v_cvt_pk_bf16_f32 v134, v136, v137
  s_waitcnt vmcnt(5)
  buffer_load_dwordx4 v[228:231], v2, s[24:27], s78 offen offset:256 nt
  v_cvt_pk_bf16_f32 v135, v138, v139
  s_nop 1
  v_mfma_f32_16x16x32_bf16 v[36:39], v[124:127], v[16:19], v[32:35]
  v_mfma_f32_16x16x32_bf16 v[36:39], v[132:135], v[20:23], v[36:39]
  v_mfma_f32_16x16x32_bf16 v[36:39], v[124:127], v[24:27], v[36:39]
  v_mfma_f32_16x16x32_bf16 v[36:39], v[132:135], v[28:31], v[36:39]
  s_waitcnt vmcnt(19)
  v_cvt_f32_i32 v140, v140
  s_waitcnt vmcnt(5)
  buffer_load_dwordx4 v[232:235], v2, s[24:27], s78 offen offset:384 nt
  v_cvt_f32_i32 v141, v141
  v_cvt_f32_i32 v142, v142
  v_cvt_f32_i32 v143, v143
  v_cvt_f32_i32 v144, v144
  v_cvt_f32_i32 v145, v145
  v_cvt_f32_i32 v146, v146
  v_cvt_f32_i32 v147, v147
  v_cvt_f32_i32 v148, v148
  s_waitcnt vmcnt(4)
  buffer_load_dwordx4 v[236:239], v2, s[24:27], s79 offen offset:0 nt
  v_cvt_f32_i32 v149, v149
  v_cvt_f32_i32 v150, v150
  v_cvt_f32_i32 v151, v151
  v_cvt_f32_i32 v152, v152
  v_cvt_f32_i32 v153, v153
  v_cvt_f32_i32 v154, v154
  v_cvt_f32_i32 v155, v155
  v_cvt_pk_bf16_f32 v140, v140, v141
  s_waitcnt vmcnt(4)
  buffer_load_dwordx4 v[240:243], v2, s[24:27], s79 offen offset:128 nt
  v_cvt_pk_bf16_f32 v141, v142, v143
  v_cvt_pk_bf16_f32 v142, v144, v145
  v_cvt_pk_bf16_f32 v143, v146, v147
  v_cvt_pk_bf16_f32 v148, v148, v149
  v_cvt_pk_bf16_f32 v149, v150, v151
  v_cvt_pk_bf16_f32 v150, v152, v153
  v_cvt_pk_bf16_f32 v151, v154, v155
  v_add_f32_dpp v52, v37, v36 row_ror:8 row_mask:0xf bank_mask:0xf
  s_waitcnt vmcnt(5)
  buffer_load_dwordx4 v[244:247], v2, s[24:27], s79 offen offset:256 nt
  v_add_f32_dpp v53, v39, v38 row_ror:8 row_mask:0xf bank_mask:0xf
  v_mfma_f32_16x16x32_bf16 v[40:43], v[140:143], v[16:19], v[32:35]
  v_mfma_f32_16x16x32_bf16 v[40:43], v[148:151], v[20:23], v[40:43]
  v_mfma_f32_16x16x32_bf16 v[40:43], v[140:143], v[24:27], v[40:43]
  v_mfma_f32_16x16x32_bf16 v[40:43], v[148:151], v[28:31], v[40:43]
  s_waitcnt vmcnt(19)
  v_cvt_f32_i32 v156, v156
  v_cvt_f32_i32 v157, v157
  s_waitcnt vmcnt(5)
  buffer_load_dwordx4 v[248:251], v2, s[24:27], s79 offen offset:384 nt
  v_cvt_f32_i32 v158, v158
  v_cvt_f32_i32 v159, v159
  v_cvt_f32_i32 v160, v160
  v_cvt_f32_i32 v161, v161
  v_cvt_f32_i32 v162, v162
  v_cvt_f32_i32 v163, v163
  v_cvt_f32_i32 v164, v164
  v_cvt_f32_i32 v165, v165
  v_cvt_f32_i32 v166, v166
  v_cvt_f32_i32 v167, v167
  v_cvt_f32_i32 v168, v168
  v_cvt_f32_i32 v169, v169
  v_cvt_f32_i32 v170, v170
  v_cvt_f32_i32 v171, v171
  v_cvt_pk_bf16_f32 v156, v156, v157
  v_cvt_pk_bf16_f32 v157, v158, v159
  v_cvt_pk_bf16_f32 v158, v160, v161
  v_cvt_pk_bf16_f32 v159, v162, v163
  v_cvt_pk_bf16_f32 v164, v164, v165
  v_cvt_pk_bf16_f32 v165, v166, v167
  v_cvt_pk_bf16_f32 v166, v168, v169
  v_cvt_pk_bf16_f32 v167, v170, v171
  v_add_f32_dpp v54, v41, v40 row_ror:8 row_mask:0xf bank_mask:0xf
  v_add_f32_dpp v55, v43, v42 row_ror:8 row_mask:0xf bank_mask:0xf
  v_mfma_f32_16x16x32_bf16 v[44:47], v[156:159], v[16:19], v[32:35]
  v_mfma_f32_16x16x32_bf16 v[44:47], v[164:167], v[20:23], v[44:47]
  v_mfma_f32_16x16x32_bf16 v[44:47], v[156:159], v[24:27], v[44:47]
  v_mfma_f32_16x16x32_bf16 v[44:47], v[164:167], v[28:31], v[44:47]
  s_waitcnt vmcnt(16)
  v_cvt_f32_i32 v172, v172
  v_cvt_f32_i32 v173, v173
  v_cvt_f32_i32 v174, v174
  v_cvt_f32_i32 v175, v175
  v_cvt_f32_i32 v176, v176
  v_cvt_f32_i32 v177, v177
  v_cvt_f32_i32 v178, v178
  v_cvt_f32_i32 v179, v179
  v_cvt_f32_i32 v180, v180
  v_cvt_f32_i32 v181, v181
  v_cvt_f32_i32 v182, v182
  v_cvt_f32_i32 v183, v183
  v_cvt_f32_i32 v184, v184
  v_cvt_f32_i32 v185, v185
  v_cvt_f32_i32 v186, v186
  v_cvt_f32_i32 v187, v187
  v_cvt_pk_bf16_f32 v172, v172, v173
  v_cvt_pk_bf16_f32 v173, v174, v175
  v_cvt_pk_bf16_f32 v174, v176, v177
  v_cvt_pk_bf16_f32 v175, v178, v179
  v_cvt_pk_bf16_f32 v180, v180, v181
  v_cvt_pk_bf16_f32 v181, v182, v183
  v_cvt_pk_bf16_f32 v182, v184, v185
  v_cvt_pk_bf16_f32 v183, v186, v187
  v_add_f32_dpp v56, v45, v44 row_ror:8 row_mask:0xf bank_mask:0xf
  v_add_f32_dpp v57, v47, v46 row_ror:8 row_mask:0xf bank_mask:0xf
  v_mfma_f32_16x16x32_bf16 v[48:51], v[172:175], v[16:19], v[32:35]
  v_mfma_f32_16x16x32_bf16 v[48:51], v[180:183], v[20:23], v[48:51]
  v_mfma_f32_16x16x32_bf16 v[48:51], v[172:175], v[24:27], v[48:51]
  v_mfma_f32_16x16x32_bf16 v[48:51], v[180:183], v[28:31], v[48:51]
  v_add_u32 v6, s60, v5
  ds_read_b128 v[16:19], v6 offset:0
  ds_read_b128 v[20:23], v6 offset:1024
  ds_read_b128 v[24:27], v6 offset:2048
  ds_read_b128 v[28:31], v6 offset:3072
  ds_read_b128 v[32:35], v6 offset:4096
  v_add_u32 v7, s52, v254
  v_max3_f32 v14, v14, v52, v53
  v_max3_f32 v14, v14, v54, v55
  v_max3_f32 v14, v14, v56, v57
  v_add_f32_dpp v58, v49, v48 row_ror:8 row_mask:0xf bank_mask:0xf
  v_add_f32_dpp v59, v51, v50 row_ror:8 row_mask:0xf bank_mask:0xf
  v_max3_f32 v14, v14, v58, v59
  s_mov_b64 exec, s[44:45]
  ds_write_b128 v7, v[52:55]
  ds_write_b128 v7, v[56:59] offset:16
  s_mov_b64 exec, -1
  s_mov_b32 s53, 3
L_kloop:
  s_lshl_b32 s52, s54, 10
  s_add_u32 s54, s54, 1
  s_and_b32 s54, s54, 7
  s_lshl_b32 s76, s54, 17
  s_add_u32 s76, s76, s51
  s_add_u32 s77, s76, 16384
  s_add_u32 s78, s76, 32768
  s_add_u32 s79, s76, 49152
  s_mul_i32 s60, s54, 5632
  s_waitcnt vmcnt(12) lgkmcnt(0)
  v_cvt_f32_i32 v188, v188
  v_cvt_f32_i32 v189, v189
  v_cvt_f32_i32 v190, v190
  v_cvt_f32_i32 v191, v191
  v_cvt_f32_i32 v192, v192
  v_cvt_f32_i32 v193, v193
  v_cvt_f32_i32 v194, v194
  s_waitcnt vmcnt(4)
  buffer_load_dwordx4 v[124:127], v2, s[24:27], s76 offen offset:0 nt
  v_cvt_f32_i32 v195, v195
  v_cvt_f32_i32 v196, v196
  v_cvt_f32_i32 v197, v197
  v_cvt_f32_i32 v198, v198
  v_cvt_f32_i32 v199, v199
  v_cvt_f32_i32 v200, v200
  v_cvt_f32_i32 v201, v201
  v_cvt_f32_i32 v202, v202
  s_waitcnt vmcnt(4)
  buffer_load_dwordx4 v[128:131], v2, s[24:27], s76 offen offset:128 nt
  v_cvt_f32_i32 v203, v203
  v_cvt_pk_bf16_f32 v188, v188, v189
  v_cvt_pk_bf16_f32 v189, v190, v191
  v_cvt_pk_bf16_f32 v190, v192, v193
  v_cvt_pk_bf16_f32 v191, v194, v195
  v_cvt_pk_bf16_f32 v196, v196, v197
  v_cvt_pk_bf16_f32 v197, v198, v199
  v_cvt_pk_bf16_f32 v198, v200, v201
  s_waitcnt vmcnt(5)
  buffer_load_dwordx4 v[132:135], v2, s[24:27], s76 offen offset:256 nt
  v_cvt_pk_bf16_f32 v199, v202, v203
  s_nop 1
  v_mfma_f32_16x16x32_bf16 v[36:39], v[188:191], v[16:19], v[32:35]
  v_mfma_f32_16x16x32_bf16 v[36:39], v[196:199], v[20:23], v[36:39]
  v_mfma_f32_16x16x32_bf16 v[36:39], v[188:191], v[24:27], v[36:39]
  v_mfma_f32_16x16x32_bf16 v[36:39], v[196:199], v[28:31], v[36:39]
  s_waitcnt vmcnt(11)
  v_cvt_f32_i32 v204, v204
  s_waitcnt vmcnt(5)
  buffer_load_dwordx4 v[136:139], v2, s[24:27], s76 offen offset:384 nt
  v_cvt_f32_i32 v205, v205
  v_cvt_f32_i32 v206, v206
  v_cvt_f32_i32 v207, v207
  v_cvt_f32_i32 v208, v208
  v_cvt_f32_i32 v209, v209
  v_cvt_f32_i32 v210, v210
  v_cvt_f32_i32 v211, v211
  v_cvt_f32_i32 v212, v212
  s_waitcnt vmcnt(4)
  buffer_load_dwordx4 v[140:143], v2, s[24:27], s77 offen offset:0 nt
  v_cvt_f32_i32 v213, v213
  v_cvt_f32_i32 v214, v214
  v_cvt_f32_i32 v215, v215
  v_cvt_f32_i32 v216, v216
  v_cvt_f32_i32 v217, v217
  v_cvt_f32_i32 v218, v218
  v_cvt_f32_i32 v219, v219
  v_cvt_pk_bf16_f32 v204, v204, v205
  s_waitcnt vmcnt(4)
  buffer_load_dwordx4 v[144:147], v2, s[24:27], s77 offen offset:128 nt
  v_cvt_pk_bf16_f32 v205, v206, v207
  v_cvt_pk_bf16_f32 v206, v208, v209
  v_cvt_pk_bf16_f32 v207, v210, v211
  v_cvt_pk_bf16_f32 v212, v212, v213
  v_cvt_pk_bf16_f32 v213, v214, v215
  v_cvt_pk_bf16_f32 v214, v216, v217
  v_cvt_pk_bf16_f32 v215, v218, v219
  v_add_f32_dpp v52, v37, v36 row_ror:8 row_mask:0xf bank_mask:0xf
  s_waitcnt vmcnt(5)
  buffer_load_dwordx4 v[148:151], v2, s[24:27], s77 offen offset:256 nt
  v_add_f32_dpp v53, v39, v38 row_ror:8 row_mask:0xf bank_mask:0xf
  v_mfma_f32_16x16x32_bf16 v[40:43], v[204:207], v[16:19], v[32:35]
  v_mfma_f32_16x16x32_bf16 v[40:43], v[212:215], v[20:23], v[40:43]
  v_mfma_f32_16x16x32_bf16 v[40:43], v[204:207], v[24:27], v[40:43]
  v_mfma_f32_16x16x32_bf16 v[40:43], v[212:215], v[28:31], v[40:43]
  s_waitcnt vmcnt(11)
  v_cvt_f32_i32 v220, v220
  v_cvt_f32_i32 v221, v221
  s_waitcnt vmcnt(5)
  buffer_load_dwordx4 v[152:155], v2, s[24:27], s77 offen offset:384 nt
  v_cvt_f32_i32 v222, v222
  v_cvt_f32_i32 v223, v223
  v_cvt_f32_i32 v224, v224
  v_cvt_f32_i32 v225, v225
  v_cvt_f32_i32 v226, v226
  v_cvt_f32_i32 v227, v227
  v_cvt_f32_i32 v228, v228
  v_cvt_f32_i32 v229, v229
  s_waitcnt vmcnt(4)
  buffer_load_dwordx4 v[156:159], v2, s[24:27], s78 offen offset:0 nt
  v_cvt_f32_i32 v230, v230
  v_cvt_f32_i32 v231, v231
  v_cvt_f32_i32 v232, v232
  v_cvt_f32_i32 v233, v233
  v_cvt_f32_i32 v234, v234
  v_cvt_f32_i32 v235, v235
  v_cvt_pk_bf16_f32 v220, v220, v221
  v_cvt_pk_bf16_f32 v221, v222, v223
  s_waitcnt vmcnt(4)
  buffer_load_dwordx4 v[160:163], v2, s[24:27], s78 offen offset:128 nt
  v_cvt_pk_bf16_f32 v222, v224, v225
  v_cvt_pk_bf16_f32 v223, v226, v227
  v_cvt_pk_bf16_f32 v228, v228, v229
  v_cvt_pk_bf16_f32 v229, v230, v231
  v_cvt_pk_bf16_f32 v230, v232, v233
  v_cvt_pk_bf16_f32 v231, v234, v235
  v_add_f32_dpp v54, v41, v40 row_ror:8 row_mask:0xf bank_mask:0xf
  v_add_f32_dpp v55, v43, v42 row_ror:8 row_mask:0xf bank_mask:0xf
  s_waitcnt vmcnt(5)
  buffer_load_dwordx4 v[164:167], v2, s[24:27], s78 offen offset:256 nt
  v_mfma_f32_16x16x32_bf16 v[44:47], v[220:223], v[16:19], v[32:35]
  v_mfma_f32_16x16x32_bf16 v[44:47], v[228:231], v[20:23], v[44:47]
  v_mfma_f32_16x16x32_bf16 v[44:47], v[220:223], v[24:27], v[44:47]
  v_mfma_f32_16x16x32_bf16 v[44:47], v[228:231], v[28:31], v[44:47]
  s_waitcnt vmcnt(11)
  v_cvt_f32_i32 v236, v236
  v_cvt_f32_i32 v237, v237
  v_cvt_f32_i32 v238, v238
  s_waitcnt vmcnt(5)
  buffer_load_dwordx4 v[168:171], v2, s[24:27], s78 offen offset:384 nt
  v_cvt_f32_i32 v239, v239
  v_cvt_f32_i32 v240, v240
  v_cvt_f32_i32 v241, v241
  v_cvt_f32_i32 v242, v242
  v_cvt_f32_i32 v243, v243
  v_cvt_f32_i32 v244, v244
  v_cvt_f32_i32 v245, v245
  v_cvt_f32_i32 v246, v246
  s_waitcnt vmcnt(4)
  buffer_load_dwordx4 v[172:175], v2, s[24:27], s79 offen offset:0 nt
  v_cvt_f32_i32 v247, v247
  v_cvt_f32_i32 v248, v248
  v_cvt_f32_i32 v249, v249
  v_cvt_f32_i32 v250, v250
  v_cvt_f32_i32 v251, v251
  v_cvt_pk_bf16_f32 v236, v236, v237
  v_cvt_pk_bf16_f32 v237, v238, v239
  v_cvt_pk_bf16_f32 v238, v240, v241
  s_waitcnt vmcnt(4)
  buffer_load_dwordx4 v[176:179], v2, s[24:27], s79 offen offset:128 nt
  v_cvt_pk_bf16_f32 v239, v242, v243
  v_cvt_pk_bf16_f32 v244, v244, v245
  v_cvt_pk_bf16_f32 v245, v246, v247
  v_cvt_pk_bf16_f32 v246, v248, v249
  v_cvt_pk_bf16_f32 v247, v250, v251
  v_add_f32_dpp v56, v45, v44 row_ror:8 row_mask:0xf bank_mask:0xf
  v_add_f32_dpp v57, v47, v46 row_ror:8 row_mask:0xf bank_mask:0xf
  v_mfma_f32_16x16x32_bf16 v[48:51], v[236:239], v[16:19], v[32:35]
  s_waitcnt vmcnt(5)
  buffer_load_dwordx4 v[180:183], v2, s[24:27], s79 offen offset:256 nt
  v_mfma_f32_16x16x32_bf16 v[48:51], v[244:247], v[20:23], v[48:51]
  v_mfma_f32_16x16x32_bf16 v[48:51], v[236:239], v[24:27], v[48:51]
  v_mfma_f32_16x16x32_bf16 v[48:51], v[244:247], v[28:31], v[48:51]
  v_add_u32 v6, s60, v5
  ds_read_b128 v[16:19], v6 offset:0
  ds_read_b128 v[20:23], v6 offset:1024
  ds_read_b128 v[24:27], v6 offset:2048
  ds_read_b128 v[28:31], v6 offset:3072
  s_waitcnt vmcnt(5)
  buffer_load_dwordx4 v[184:187], v2, s[24:27], s79 offen offset:384 nt
  ds_read_b128 v[32:35], v6 offset:4096
  v_add_u32 v7, s52, v254
  v_max3_f32 v14, v14, v52, v53
  v_max3_f32 v14, v14, v54, v55
  v_max3_f32 v14, v14, v56, v57
  v_add_f32_dpp v58, v49, v48 row_ror:8 row_mask:0xf bank_mask:0xf
  v_add_f32_dpp v59, v51, v50 row_ror:8 row_mask:0xf bank_mask:0xf
  v_max3_f32 v14, v14, v58, v59
  s_mov_b64 exec, s[44:45]
  ds_write_b128 v7, v[52:55]
  ds_write_b128 v7, v[56:59] offset:16
  s_mov_b64 exec, -1
  s_lshl_b32 s52, s54, 10
  s_add_u32 s54, s54, 1
  s_and_b32 s54, s54, 7
  s_lshl_b32 s76, s54, 17
  s_add_u32 s76, s76, s51
  s_add_u32 s77, s76, 16384
  s_add_u32 s78, s76, 32768
  s_add_u32 s79, s76, 49152
  s_mul_i32 s60, s54, 5632
  s_waitcnt vmcnt(12) lgkmcnt(0)
  v_cvt_f32_i32 v124, v124
  v_cvt_f32_i32 v125, v125
  v_cvt_f32_i32 v126, v126
  v_cvt_f32_i32 v127, v127
  v_cvt_f32_i32 v128, v128
  v_cvt_f32_i32 v129, v129
  v_cvt_f32_i32 v130, v130
  s_waitcnt vmcnt(4)
  buffer_load_dwordx4 v[188:191], v2, s[24:27], s76 offen offset:0 nt
  v_cvt_f32_i32 v131, v131
  v_cvt_f32_i32 v132, v132
  v_cvt_f32_i32 v133, v133
  v_cvt_f32_i32 v134, v134
  v_cvt_f32_i32 v135, v135
  v_cvt_f32_i32 v136, v136
  v_cvt_f32_i32 v137, v137
  v_cvt_f32_i32 v138, v138
  s_waitcnt vmcnt(4)
  buffer_load_dwordx4 v[192:195], v2, s[24:27], s76 offen offset:128 nt
  v_cvt_f32_i32 v139, v139
  v_cvt_pk_bf16_f32 v124, v124, v125
  v_cvt_pk_bf16_f32 v125, v126, v127
  v_cvt_pk_bf16_f32 v126, v128, v129
  v_cvt_pk_bf16_f32 v127, v130, v131
  v_cvt_pk_bf16_f32 v132, v132, v133
  v_cvt_pk_bf16_f32 v133, v134, v135
  v_cvt_pk_bf16_f32 v134, v136, v137
  s_waitcnt vmcnt(5)
  buffer_load_dwordx4 v[196:199], v2, s[24:27], s76 offen offset:256 nt
  v_cvt_pk_bf16_f32 v135, v138, v139
  s_nop 1
  v_mfma_f32_16x16x32_bf16 v[36:39], v[124:127], v[16:19], v[32:35]
  v_mfma_f32_16x16x32_bf16 v[36:39], v[132:135], v[20:23], v[36:39]
  v_mfma_f32_16x16x32_bf16 v[36:39], v[124:127], v[24:27], v[36:39]
  v_mfma_f32_16x16x32_bf16 v[36:39], v[132:135], v[28:31], v[36:39]
  s_waitcnt vmcnt(11)
  v_cvt_f32_i32 v140, v140
  s_waitcnt vmcnt(5)
  buffer_load_dwordx4 v[200:203], v2, s[24:27], s76 offen offset:384 nt
  v_cvt_f32_i32 v141, v141
  v_cvt_f32_i32 v142, v142
  v_cvt_f32_i32 v143, v143
  v_cvt_f32_i32 v144, v144
  v_cvt_f32_i32 v145, v145
  v_cvt_f32_i32 v146, v146
  v_cvt_f32_i32 v147, v147
  v_cvt_f32_i32 v148, v148
  s_waitcnt vmcnt(4)
  buffer_load_dwordx4 v[204:207], v2, s[24:27], s77 offen offset:0 nt
  v_cvt_f32_i32 v149, v149
  v_cvt_f32_i32 v150, v150
  v_cvt_f32_i32 v151, v151
  v_cvt_f32_i32 v152, v152
  v_cvt_f32_i32 v153, v153
  v_cvt_f32_i32 v154, v154
  v_cvt_f32_i32 v155, v155
  v_cvt_pk_bf16_f32 v140, v140, v141
  s_waitcnt vmcnt(4)
  buffer_load_dwordx4 v[208:211], v2, s[24:27], s77 offen offset:128 nt
  v_cvt_pk_bf16_f32 v141, v142, v143
  v_cvt_pk_bf16_f32 v142, v144, v145
  v_cvt_pk_bf16_f32 v143, v146, v147
  v_cvt_pk_bf16_f32 v148, v148, v149
  v_cvt_pk_bf16_f32 v149, v150, v151
  v_cvt_pk_bf16_f32 v150, v152, v153
  v_cvt_pk_bf16_f32 v151, v154, v155
  v_add_f32_dpp v52, v37, v36 row_ror:8 row_mask:0xf bank_mask:0xf
  s_waitcnt vmcnt(5)
  buffer_load_dwordx4 v[212:215], v2, s[24:27], s77 offen offset:256 nt
  v_add_f32_dpp v53, v39, v38 row_ror:8 row_mask:0xf bank_mask:0xf
  v_mfma_f32_16x16x32_bf16 v[40:43], v[140:143], v[16:19], v[32:35]
  v_mfma_f32_16x16x32_bf16 v[40:43], v[148:151], v[20:23], v[40:43]
  v_mfma_f32_16x16x32_bf16 v[40:43], v[140:143], v[24:27], v[40:43]
  v_mfma_f32_16x16x32_bf16 v[40:43], v[148:151], v[28:31], v[40:43]
  s_waitcnt vmcnt(11)
  v_cvt_f32_i32 v156, v156
  v_cvt_f32_i32 v157, v157
  s_waitcnt vmcnt(5)
  buffer_load_dwordx4 v[216:219], v2, s[24:27], s77 offen offset:384 nt
  v_cvt_f32_i32 v158, v158
  v_cvt_f32_i32 v159, v159
  v_cvt_f32_i32 v160, v160
  v_cvt_f32_i32 v161, v161
  v_cvt_f32_i32 v162, v162
  v_cvt_f32_i32 v163, v163
  v_cvt_f32_i32 v164, v164
  v_cvt_f32_i32 v165, v165
  s_waitcnt vmcnt(4)
  buffer_load_dwordx4 v[220:223], v2, s[24:27], s78 offen offset:0 nt
  v_cvt_f32_i32 v166, v166
  v_cvt_f32_i32 v167, v167
  v_cvt_f32_i32 v168, v168
  v_cvt_f32_i32 v169, v169
  v_cvt_f32_i32 v170, v170
  v_cvt_f32_i32 v171, v171
  v_cvt_pk_bf16_f32 v156, v156, v157
  v_cvt_pk_bf16_f32 v157, v158, v159
  s_waitcnt vmcnt(4)
  buffer_load_dwordx4 v[224:227], v2, s[24:27], s78 offen offset:128 nt
  v_cvt_pk_bf16_f32 v158, v160, v161
  v_cvt_pk_bf16_f32 v159, v162, v163
  v_cvt_pk_bf16_f32 v164, v164, v165
  v_cvt_pk_bf16_f32 v165, v166, v167
  v_cvt_pk_bf16_f32 v166, v168, v169
  v_cvt_pk_bf16_f32 v167, v170, v171
  v_add_f32_dpp v54, v41, v40 row_ror:8 row_mask:0xf bank_mask:0xf
  v_add_f32_dpp v55, v43, v42 row_ror:8 row_mask:0xf bank_mask:0xf
  s_waitcnt vmcnt(5)
  buffer_load_dwordx4 v[228:231], v2, s[24:27], s78 offen offset:256 nt
  v_mfma_f32_16x16x32_bf16 v[44:47], v[156:159], v[16:19], v[32:35]
  v_mfma_f32_16x16x32_bf16 v[44:47], v[164:167], v[20:23], v[44:47]
  v_mfma_f32_16x16x32_bf16 v[44:47], v[156:159], v[24:27], v[44:47]
  v_mfma_f32_16x16x32_bf16 v[44:47], v[164:167], v[28:31], v[44:47]
  s_waitcnt vmcnt(11)
  v_cvt_f32_i32 v172, v172
  v_cvt_f32_i32 v173, v173
  v_cvt_f32_i32 v174, v174
  s_waitcnt vmcnt(5)
  buffer_load_dwordx4 v[232:235], v2, s[24:27], s78 offen offset:384 nt
  v_cvt_f32_i32 v175, v175
  v_cvt_f32_i32 v176, v176
  v_cvt_f32_i32 v177, v177
  v_cvt_f32_i32 v178, v178
  v_cvt_f32_i32 v179, v179
  v_cvt_f32_i32 v180, v180
  v_cvt_f32_i32 v181, v181
  v_cvt_f32_i32 v182, v182
  s_waitcnt vmcnt(4)
  buffer_load_dwordx4 v[236:239], v2, s[24:27], s79 offen offset:0 nt
  v_cvt_f32_i32 v183, v183
  v_cvt_f32_i32 v184, v184
  v_cvt_f32_i32 v185, v185
  v_cvt_f32_i32 v186, v186
  v_cvt_f32_i32 v187, v187
  v_cvt_pk_bf16_f32 v172, v172, v173
  v_cvt_pk_bf16_f32 v173, v174, v175
  v_cvt_pk_bf16_f32 v174, v176, v177
  s_waitcnt vmcnt(4)
  buffer_load_dwordx4 v[240:243], v2, s[24:27], s79 offen offset:128 nt
  v_cvt_pk_bf16_f32 v175, v178, v179
  v_cvt_pk_bf16_f32 v180, v180, v181
  v_cvt_pk_bf16_f32 v181, v182, v183
  v_cvt_pk_bf16_f32 v182, v184, v185
  v_cvt_pk_bf16_f32 v183, v186, v187
  v_add_f32_dpp v56, v45, v44 row_ror:8 row_mask:0xf bank_mask:0xf
  v_add_f32_dpp v57, v47, v46 row_ror:8 row_mask:0xf bank_mask:0xf
  v_mfma_f32_16x16x32_bf16 v[48:51], v[172:175], v[16:19], v[32:35]
  s_waitcnt vmcnt(5)
  buffer_load_dwordx4 v[244:247], v2, s[24:27], s79 offen offset:256 nt
  v_mfma_f32_16x16x32_bf16 v[48:51], v[180:183], v[20:23], v[48:51]
  v_mfma_f32_16x16x32_bf16 v[48:51], v[172:175], v[24:27], v[48:51]
  v_mfma_f32_16x16x32_bf16 v[48:51], v[180:183], v[28:31], v[48:51]
  v_add_u32 v6, s60, v5
  ds_read_b128 v[16:19], v6 offset:0
  ds_read_b128 v[20:23], v6 offset:1024
  ds_read_b128 v[24:27], v6 offset:2048
  ds_read_b128 v[28:31], v6 offset:3072
  s_waitcnt vmcnt(5)
  buffer_load_dwordx4 v[248:251], v2, s[24:27], s79 offen offset:384 nt
  ds_read_b128 v[32:35], v6 offset:4096
  v_add_u32 v7, s52, v254
  v_max3_f32 v14, v14, v52, v53
  v_max3_f32 v14, v14, v54, v55
  v_max3_f32 v14, v14, v56, v57
  v_add_f32_dpp v58, v49, v48 row_ror:8 row_mask:0xf bank_mask:0xf
  v_add_f32_dpp v59, v51, v50 row_ror:8 row_mask:0xf bank_mask:0xf
  v_max3_f32 v14, v14, v58, v59
  s_mov_b64 exec, s[44:45]
  ds_write_b128 v7, v[52:55]
  ds_write_b128 v7, v[56:59] offset:16
  s_mov_b64 exec, -1
  s_sub_u32 s53, s53, 1
  s_cmp_lg_u32 s53, 0
  s_cbranch_scc1 L_kloop
  s_lshl_b32 s52, s54, 10
  s_add_u32 s54, s54, 1
  s_and_b32 s54, s54, 7
  s_lshl_b32 s76, s54, 17
  s_add_u32 s76, s76, s51
  s_add_u32 s77, s76, 16384
  s_add_u32 s78, s76, 32768
  s_add_u32 s79, s76, 49152
  s_mul_i32 s60, s54, 5632
  s_waitcnt vmcnt(12) lgkmcnt(0)
  v_cvt_f32_i32 v188, v188
  v_cvt_f32_i32 v189, v189
  v_cvt_f32_i32 v190, v190
  v_cvt_f32_i32 v191, v191
  v_cvt_f32_i32 v192, v192
  v_cvt_f32_i32 v193, v193
  v_cvt_f32_i32 v194, v194
  s_waitcnt vmcnt(4)
  buffer_load_dwordx4 v[124:127], v3, s[28:31], s76 offen offset:0 nt
  v_cvt_f32_i32 v195, v195
  v_cvt_f32_i32 v196, v196
  v_cvt_f32_i32 v197, v197
  v_cvt_f32_i32 v198, v198
  v_cvt_f32_i32 v199, v199
  v_cvt_f32_i32 v200, v200
  v_cvt_f32_i32 v201, v201
  v_cvt_f32_i32 v202, v202
  s_waitcnt vmcnt(4)
  buffer_load_dwordx4 v[128:131], v3, s[28:31], s76 offen offset:256 nt
  v_cvt_f32_i32 v203, v203
  v_cvt_pk_bf16_f32 v188, v188, v189
  v_cvt_pk_bf16_f32 v189, v190, v191
  v_cvt_pk_bf16_f32 v190, v192, v193
  v_cvt_pk_bf16_f32 v191, v194, v195
  v_cvt_pk_bf16_f32 v196, v196, v197
  v_cvt_pk_bf16_f32 v197, v198, v199
  v_cvt_pk_bf16_f32 v198, v200, v201
  s_waitcnt vmcnt(5)
  buffer_load_dwordx4 v[132:135], v3, s[28:31], s76 offen offset:512 nt
  v_cvt_pk_bf16_f32 v199, v202, v203
  s_nop 1
  v_mfma_f32_16x16x32_bf16 v[36:39], v[188:191], v[16:19], v[32:35]
  v_mfma_f32_16x16x32_bf16 v[36:39], v[196:199], v[20:23], v[36:39]
  v_mfma_f32_16x16x32_bf16 v[36:39], v[188:191], v[24:27], v[36:39]
  v_mfma_f32_16x16x32_bf16 v[36:39], v[196:199], v[28:31], v[36:39]
  s_waitcnt vmcnt(11)
  v_cvt_f32_i32 v204, v204
  s_waitcnt vmcnt(5)
  buffer_load_dwordx4 v[136:139], v3, s[28:31], s76 offen offset:768 nt
  v_cvt_f32_i32 v205, v205
  v_cvt_f32_i32 v206, v206
  v_cvt_f32_i32 v207, v207
  v_cvt_f32_i32 v208, v208
  v_cvt_f32_i32 v209, v209
  v_cvt_f32_i32 v210, v210
  v_cvt_f32_i32 v211, v211
  v_cvt_f32_i32 v212, v212
  s_waitcnt vmcnt(4)
  buffer_load_dwordx4 v[140:143], v3, s[28:31], s77 offen offset:0 nt
  v_cvt_f32_i32 v213, v213
  v_cvt_f32_i32 v214, v214
  v_cvt_f32_i32 v215, v215
  v_cvt_f32_i32 v216, v216
  v_cvt_f32_i32 v217, v217
  v_cvt_f32_i32 v218, v218
  v_cvt_f32_i32 v219, v219
  v_cvt_pk_bf16_f32 v204, v204, v205
  s_waitcnt vmcnt(4)
  buffer_load_dwordx4 v[144:147], v3, s[28:31], s77 offen offset:256 nt
  v_cvt_pk_bf16_f32 v205, v206, v207
  v_cvt_pk_bf16_f32 v206, v208, v209
  v_cvt_pk_bf16_f32 v207, v210, v211
  v_cvt_pk_bf16_f32 v212, v212, v213
  v_cvt_pk_bf16_f32 v213, v214, v215
  v_cvt_pk_bf16_f32 v214, v216, v217
  v_cvt_pk_bf16_f32 v215, v218, v219
  v_add_f32_dpp v52, v37, v36 row_ror:8 row_mask:0xf bank_mask:0xf
  s_waitcnt vmcnt(5)
  buffer_load_dwordx4 v[148:151], v3, s[28:31], s77 offen offset:512 nt
  v_add_f32_dpp v53, v39, v38 row_ror:8 row_mask:0xf bank_mask:0xf
  v_mfma_f32_16x16x32_bf16 v[40:43], v[204:207], v[16:19], v[32:35]
  v_mfma_f32_16x16x32_bf16 v[40:43], v[212:215], v[20:23], v[40:43]
  v_mfma_f32_16x16x32_bf16 v[40:43], v[204:207], v[24:27], v[40:43]
  v_mfma_f32_16x16x32_bf16 v[40:43], v[212:215], v[28:31], v[40:43]
  s_waitcnt vmcnt(11)
  v_cvt_f32_i32 v220, v220
  v_cvt_f32_i32 v221, v221
  s_waitcnt vmcnt(5)
  buffer_load_dwordx4 v[152:155], v3, s[28:31], s77 offen offset:768 nt
  v_cvt_f32_i32 v222, v222
  v_cvt_f32_i32 v223, v223
  v_cvt_f32_i32 v224, v224
  v_cvt_f32_i32 v225, v225
  v_cvt_f32_i32 v226, v226
  v_cvt_f32_i32 v227, v227
  v_cvt_f32_i32 v228, v228
  v_cvt_f32_i32 v229, v229
  s_waitcnt vmcnt(4)
  buffer_load_dwordx4 v[156:159], v3, s[28:31], s78 offen offset:0 nt
  v_cvt_f32_i32 v230, v230
  v_cvt_f32_i32 v231, v231
  v_cvt_f32_i32 v232, v232
  v_cvt_f32_i32 v233, v233
  v_cvt_f32_i32 v234, v234
  v_cvt_f32_i32 v235, v235
  v_cvt_pk_bf16_f32 v220, v220, v221
  v_cvt_pk_bf16_f32 v221, v222, v223
  s_waitcnt vmcnt(4)
  buffer_load_dwordx4 v[160:163], v3, s[28:31], s78 offen offset:256 nt
  v_cvt_pk_bf16_f32 v222, v224, v225
  v_cvt_pk_bf16_f32 v223, v226, v227
  v_cvt_pk_bf16_f32 v228, v228, v229
  v_cvt_pk_bf16_f32 v229, v230, v231
  v_cvt_pk_bf16_f32 v230, v232, v233
  v_cvt_pk_bf16_f32 v231, v234, v235
  v_add_f32_dpp v54, v41, v40 row_ror:8 row_mask:0xf bank_mask:0xf
  v_add_f32_dpp v55, v43, v42 row_ror:8 row_mask:0xf bank_mask:0xf
  s_waitcnt vmcnt(5)
  buffer_load_dwordx4 v[164:167], v3, s[28:31], s78 offen offset:512 nt
  v_mfma_f32_16x16x32_bf16 v[44:47], v[220:223], v[16:19], v[32:35]
  v_mfma_f32_16x16x32_bf16 v[44:47], v[228:231], v[20:23], v[44:47]
  v_mfma_f32_16x16x32_bf16 v[44:47], v[220:223], v[24:27], v[44:47]
  v_mfma_f32_16x16x32_bf16 v[44:47], v[228:231], v[28:31], v[44:47]
  s_waitcnt vmcnt(11)
  v_cvt_f32_i32 v236, v236
  v_cvt_f32_i32 v237, v237
  v_cvt_f32_i32 v238, v238
  s_waitcnt vmcnt(5)
  buffer_load_dwordx4 v[168:171], v3, s[28:31], s78 offen offset:768 nt
  v_cvt_f32_i32 v239, v239
  v_cvt_f32_i32 v240, v240
  v_cvt_f32_i32 v241, v241
  v_cvt_f32_i32 v242, v242
  v_cvt_f32_i32 v243, v243
  v_cvt_f32_i32 v244, v244
  v_cvt_f32_i32 v245, v245
  v_cvt_f32_i32 v246, v246
  s_waitcnt vmcnt(4)
  buffer_load_dwordx4 v[172:175], v3, s[28:31], s79 offen offset:0 nt
  v_cvt_f32_i32 v247, v247
  v_cvt_f32_i32 v248, v248
  v_cvt_f32_i32 v249, v249
  v_cvt_f32_i32 v250, v250
  v_cvt_f32_i32 v251, v251
  v_cvt_pk_bf16_f32 v236, v236, v237
  v_cvt_pk_bf16_f32 v237, v238, v239
  v_cvt_pk_bf16_f32 v238, v240, v241
  s_waitcnt vmcnt(4)
  buffer_load_dwordx4 v[176:179], v3, s[28:31], s79 offen offset:256 nt
  v_cvt_pk_bf16_f32 v239, v242, v243
  v_cvt_pk_bf16_f32 v244, v244, v245
  v_cvt_pk_bf16_f32 v245, v246, v247
  v_cvt_pk_bf16_f32 v246, v248, v249
  v_cvt_pk_bf16_f32 v247, v250, v251
  v_add_f32_dpp v56, v45, v44 row_ror:8 row_mask:0xf bank_mask:0xf
  v_add_f32_dpp v57, v47, v46 row_ror:8 row_mask:0xf bank_mask:0xf
  v_mfma_f32_16x16x32_bf16 v[48:51], v[236:239], v[16:19], v[32:35]
  s_waitcnt vmcnt(5)
  buffer_load_dwordx4 v[180:183], v3, s[28:31], s79 offen offset:512 nt
  v_mfma_f32_16x16x32_bf16 v[48:51], v[244:247], v[20:23], v[48:51]
  v_mfma_f32_16x16x32_bf16 v[48:51], v[236:239], v[24:27], v[48:51]
  v_mfma_f32_16x16x32_bf16 v[48:51], v[244:247], v[28:31], v[48:51]
  s_nop 3
  v_add_u32 v7, s52, v254
  v_max3_f32 v14, v14, v52, v53
  v_max3_f32 v14, v14, v54, v55
  v_max3_f32 v14, v14, v56, v57
  s_waitcnt vmcnt(5)
  buffer_load_dwordx4 v[184:187], v3, s[28:31], s79 offen offset:768 nt
  v_add_f32_dpp v58, v49, v48 row_ror:8 row_mask:0xf bank_mask:0xf
  v_add_f32_dpp v59, v51, v50 row_ror:8 row_mask:0xf bank_mask:0xf
  v_max3_f32 v14, v14, v58, v59
  s_mov_b64 exec, s[44:45]
  ds_write_b128 v7, v[52:55]
  ds_write_b128 v7, v[56:59] offset:16
  s_mov_b64 exec, -1
  s_lshl_b32 s55, s54, 10
  v_add_u32 v10, s55, v254
  ds_read_b128 v[52:55], v10
  ds_read_b128 v[56:59], v10 offset:16
  v_add_u32 v9, s60, v4
  ds_read2_b32 v[116:117], v9 offset0:0 offset1:16
  ds_read2_b32 v[118:119], v9 offset0:32 offset1:48
  ds_read2_b32 v[120:121], v9 offset0:64 offset1:80
  ds_read2_b32 v[122:123], v9 offset0:96 offset1:112
  v_mov_b32 v6, v14
  s_nop 1
  v_permlane16_swap_b32 v6, v14
  v_max_f32 v14, v14, v6
  v_mov_b32 v6, v14
  s_nop 1
  v_permlane32_swap_b32 v6, v14
  v_max_f32 v14, v14, v6
  s_nop 1
  v_mov_b32_dpp v14, v14 row_ror:8 row_mask:0xf bank_mask:0xc
  v_mul_f32 v255, s47, v14
  s_mov_b32 s53, 3
L_vloop:
  s_lshl_b32 s52, s54, 10
  s_add_u32 s54, s54, 1
  s_and_b32 s54, s54, 7
  s_lshl_b32 s76, s54, 17
  s_add_u32 s76, s76, s51
  s_add_u32 s77, s76, 16384
  s_add_u32 s78, s76, 32768
  s_add_u32 s79, s76, 49152
  s_mul_i32 s60, s54, 5632
  s_waitcnt lgkmcnt(0)
  v_fma_f32 v52, v52, s46, v255
  v_fma_f32 v53, v53, s46, v255
  v_fma_f32 v54, v54, s46, v255
  v_fma_f32 v55, v55, s46, v255
  v_fma_f32 v56, v56, s46, v255
  v_fma_f32 v57, v57, s46, v255
  v_fma_f32 v58, v58, s46, v255
  v_fma_f32 v59, v59, s46, v255
  s_waitcnt vmcnt(4)
  buffer_load_dwordx4 v[188:191], v3, s[28:31], s76 offen offset:0 nt
  v_exp_f32 v52, v52
  v_exp_f32 v53, v53
  v_exp_f32 v54, v54
  v_exp_f32 v55, v55
  v_exp_f32 v56, v56
  v_exp_f32 v57, v57
  v_exp_f32 v58, v58
  v_exp_f32 v59, v59
  v_lshlrev_b32 v60, 16, v116
  s_waitcnt vmcnt(4)
  buffer_load_dwordx4 v[192:195], v3, s[28:31], s76 offen offset:256 nt
  v_and_b32 v61, 0xffff0000, v116
  v_lshlrev_b32 v62, 16, v117
  v_and_b32 v63, 0xffff0000, v117
  v_lshlrev_b32 v64, 16, v118
  v_and_b32 v65, 0xffff0000, v118
  v_lshlrev_b32 v66, 16, v119
  v_and_b32 v67, 0xffff0000, v119
  v_add_f32 v15, v15, v52
  v_add_f32 v15, v15, v53
  s_waitcnt vmcnt(5)
  buffer_load_dwordx4 v[196:199], v3, s[28:31], s76 offen offset:512 nt
  v_add_f32 v15, v15, v54
  v_add_f32 v15, v15, v55
  v_add_f32 v15, v15, v56
  v_add_f32 v15, v15, v57
  v_add_f32 v15, v15, v58
  v_add_f32 v15, v15, v59
  v_mul_f32 v52, v52, v60
  v_mul_f32 v53, v53, v61
  v_mul_f32 v54, v54, v62
  s_waitcnt vmcnt(5)
  buffer_load_dwordx4 v[200:203], v3, s[28:31], s76 offen offset:768 nt
  v_mul_f32 v55, v55, v63
  v_mul_f32 v56, v56, v64
  v_mul_f32 v57, v57, v65
  v_mul_f32 v58, v58, v66
  v_mul_f32 v59, v59, v67
  v_cvt_pk_bf16_f32 v68, v52, v53
  v_cvt_pk_bf16_f32 v69, v54, v55
  v_cvt_pk_bf16_f32 v70, v56, v57
  v_cvt_pk_bf16_f32 v71, v58, v59
  s_waitcnt vmcnt(4)
  buffer_load_dwordx4 v[204:207], v3, s[28:31], s77 offen offset:0 nt
  s_nop 1
  v_mfma_f32_16x16x32_bf16 v[112:115], v[120:123], v[68:71], v[112:115]
  s_lshl_b32 s55, s54, 10
  v_add_u32 v10, s55, v254
  ds_read_b128 v[52:55], v10
  ds_read_b128 v[56:59], v10 offset:16
  v_add_u32 v9, s60, v4
  ds_read2_b32 v[116:117], v9 offset0:0 offset1:16
  ds_read2_b32 v[118:119], v9 offset0:32 offset1:48
  s_waitcnt vmcnt(4)
  buffer_load_dwordx4 v[208:211], v3, s[28:31], s77 offen offset:256 nt
  ds_read2_b32 v[120:121], v9 offset0:64 offset1:80
  ds_read2_b32 v[122:123], v9 offset0:96 offset1:112
  s_waitcnt vmcnt(14)
  v_cvt_f32_i32 v124, v124
  v_cvt_f32_i32 v125, v125
  v_cvt_f32_i32 v126, v126
  v_cvt_f32_i32 v127, v127
  v_cvt_f32_i32 v128, v128
  v_cvt_f32_i32 v129, v129
  s_waitcnt vmcnt(5)
  buffer_load_dwordx4 v[212:215], v3, s[28:31], s77 offen offset:512 nt
  v_cvt_f32_i32 v130, v130
  v_cvt_f32_i32 v131, v131
  v_cvt_f32_i32 v132, v132
  v_cvt_f32_i32 v133, v133
  v_cvt_f32_i32 v134, v134
  v_cvt_f32_i32 v135, v135
  v_cvt_f32_i32 v136, v136
  v_cvt_f32_i32 v137, v137
  v_cvt_f32_i32 v138, v138
  s_waitcnt vmcnt(5)
  buffer_load_dwordx4 v[216:219], v3, s[28:31], s77 offen offset:768 nt
  v_cvt_f32_i32 v139, v139
  v_cvt_f32_i32 v140, v140
  v_cvt_f32_i32 v141, v141
  v_cvt_f32_i32 v142, v142
  v_cvt_f32_i32 v143, v143
  v_cvt_f32_i32 v144, v144
  v_cvt_f32_i32 v145, v145
  v_cvt_f32_i32 v146, v146
  v_cvt_f32_i32 v147, v147
  s_waitcnt vmcnt(4)
  buffer_load_dwordx4 v[220:223], v3, s[28:31], s78 offen offset:0 nt
  v_cvt_f32_i32 v148, v148
  v_cvt_f32_i32 v149, v149
  v_cvt_f32_i32 v150, v150
  v_cvt_f32_i32 v151, v151
  v_cvt_f32_i32 v152, v152
  v_cvt_f32_i32 v153, v153
  v_cvt_f32_i32 v154, v154
  v_cvt_f32_i32 v155, v155
  v_cvt_pk_bf16_f32 v36, v124, v132
  s_waitcnt vmcnt(4)
  buffer_load_dwordx4 v[224:227], v3, s[28:31], s78 offen offset:256 nt
  v_cvt_pk_bf16_f32 v37, v140, v148
  v_cvt_pk_bf16_f32 v40, v125, v133
  v_cvt_pk_bf16_f32 v41, v141, v149
  v_cvt_pk_bf16_f32 v44, v126, v134
  v_cvt_pk_bf16_f32 v45, v142, v150
  v_cvt_pk_bf16_f32 v48, v127, v135
  v_cvt_pk_bf16_f32 v49, v143, v151
  v_cvt_pk_bf16_f32 v60, v128, v136
  v_cvt_pk_bf16_f32 v61, v144, v152
  s_waitcnt vmcnt(5)
  buffer_load_dwordx4 v[228:231], v3, s[28:31], s78 offen offset:512 nt
  v_cvt_pk_bf16_f32 v64, v129, v137
  v_cvt_pk_bf16_f32 v65, v145, v153
  v_cvt_pk_bf16_f32 v72, v130, v138
  v_cvt_pk_bf16_f32 v73, v146, v154
  v_cvt_pk_bf16_f32 v76, v131, v139
  v_cvt_pk_bf16_f32 v77, v147, v155
  s_waitcnt vmcnt(11)
  v_cvt_f32_i32 v156, v156
  v_cvt_f32_i32 v157, v157
  s_waitcnt vmcnt(5)
  buffer_load_dwordx4 v[232:235], v3, s[28:31], s78 offen offset:768 nt
  v_cvt_f32_i32 v158, v158
  v_cvt_f32_i32 v159, v159
  v_cvt_f32_i32 v160, v160
  v_cvt_f32_i32 v161, v161
  v_cvt_f32_i32 v162, v162
  v_cvt_f32_i32 v163, v163
  v_cvt_f32_i32 v164, v164
  v_cvt_f32_i32 v165, v165
  v_cvt_f32_i32 v166, v166
  s_waitcnt vmcnt(4)
  buffer_load_dwordx4 v[236:239], v3, s[28:31], s79 offen offset:0 nt
  v_cvt_f32_i32 v167, v167
  v_cvt_f32_i32 v168, v168
  v_cvt_f32_i32 v169, v169
  v_cvt_f32_i32 v170, v170
  v_cvt_f32_i32 v171, v171
  v_cvt_f32_i32 v172, v172
  v_cvt_f32_i32 v173, v173
  v_cvt_f32_i32 v174, v174
  v_cvt_f32_i32 v175, v175
  s_waitcnt vmcnt(4)
  buffer_load_dwordx4 v[240:243], v3, s[28:31], s79 offen offset:256 nt
  v_cvt_f32_i32 v176, v176
  v_cvt_f32_i32 v177, v177
  v_cvt_f32_i32 v178, v178
  v_cvt_f32_i32 v179, v179
  v_cvt_f32_i32 v180, v180
  v_cvt_f32_i32 v181, v181
  v_cvt_f32_i32 v182, v182
  v_cvt_f32_i32 v183, v183
  v_cvt_f32_i32 v184, v184
  s_waitcnt vmcnt(5)
  buffer_load_dwordx4 v[244:247], v3, s[28:31], s79 offen offset:512 nt
  v_cvt_f32_i32 v185, v185
  v_cvt_f32_i32 v186, v186
  v_cvt_f32_i32 v187, v187
  v_cvt_pk_bf16_f32 v38, v156, v164
  v_cvt_pk_bf16_f32 v39, v172, v180
  v_cvt_pk_bf16_f32 v42, v157, v165
  v_cvt_pk_bf16_f32 v43, v173, v181
  v_mfma_f32_16x16x32_bf16 v[80:83], v[36:39], v[68:71], v[80:83]
  v_cvt_pk_bf16_f32 v46, v158, v166
  s_waitcnt vmcnt(5)
  buffer_load_dwordx4 v[248:251], v3, s[28:31], s79 offen offset:768 nt
  v_cvt_pk_bf16_f32 v47, v174, v182
  v_mfma_f32_16x16x32_bf16 v[84:87], v[40:43], v[68:71], v[84:87]
  v_cvt_pk_bf16_f32 v50, v159, v167
  v_cvt_pk_bf16_f32 v51, v175, v183
  v_mfma_f32_16x16x32_bf16 v[88:91], v[44:47], v[68:71], v[88:91]
  v_cvt_pk_bf16_f32 v62, v160, v168
  v_cvt_pk_bf16_f32 v63, v176, v184
  v_mfma_f32_16x16x32_bf16 v[92:95], v[48:51], v[68:71], v[92:95]
  v_cvt_pk_bf16_f32 v66, v161, v169
  v_cvt_pk_bf16_f32 v67, v177, v185
  v_mfma_f32_16x16x32_bf16 v[96:99], v[60:63], v[68:71], v[96:99]
  v_cvt_pk_bf16_f32 v74, v162, v170
  v_cvt_pk_bf16_f32 v75, v178, v186
  v_mfma_f32_16x16x32_bf16 v[100:103], v[64:67], v[68:71], v[100:103]
  v_cvt_pk_bf16_f32 v78, v163, v171
  v_cvt_pk_bf16_f32 v79, v179, v187
  v_mfma_f32_16x16x32_bf16 v[104:107], v[72:75], v[68:71], v[104:107]
  s_nop 0
  v_mfma_f32_16x16x32_bf16 v[108:111], v[76:79], v[68:71], v[108:111]
  s_lshl_b32 s52, s54, 10
  s_add_u32 s54, s54, 1
  s_and_b32 s54, s54, 7
  s_lshl_b32 s76, s54, 17
  s_add_u32 s76, s76, s51
  s_add_u32 s77, s76, 16384
  s_add_u32 s78, s76, 32768
  s_add_u32 s79, s76, 49152
  s_mul_i32 s60, s54, 5632
  s_waitcnt lgkmcnt(0)
  v_fma_f32 v52, v52, s46, v255
  v_fma_f32 v53, v53, s46, v255
  v_fma_f32 v54, v54, s46, v255
  v_fma_f32 v55, v55, s46, v255
  v_fma_f32 v56, v56, s46, v255
  v_fma_f32 v57, v57, s46, v255
  v_fma_f32 v58, v58, s46, v255
  v_fma_f32 v59, v59, s46, v255
  s_waitcnt vmcnt(4)
  buffer_load_dwordx4 v[124:127], v3, s[28:31], s76 offen offset:0 nt
  v_exp_f32 v52, v52
  v_exp_f32 v53, v53
  v_exp_f32 v54, v54
  v_exp_f32 v55, v55
  v_exp_f32 v56, v56
  v_exp_f32 v57, v57
  v_exp_f32 v58, v58
  v_exp_f32 v59, v59
  v_lshlrev_b32 v60, 16, v116
  s_waitcnt vmcnt(4)
  buffer_load_dwordx4 v[128:131], v3, s[28:31], s76 offen offset:256 nt
  v_and_b32 v61, 0xffff0000, v116
  v_lshlrev_b32 v62, 16, v117
  v_and_b32 v63, 0xffff0000, v117
  v_lshlrev_b32 v64, 16, v118
  v_and_b32 v65, 0xffff0000, v118
  v_lshlrev_b32 v66, 16, v119
  v_and_b32 v67, 0xffff0000, v119
  v_add_f32 v15, v15, v52
  v_add_f32 v15, v15, v53
  s_waitcnt vmcnt(5)
  buffer_load_dwordx4 v[132:135], v3, s[28:31], s76 offen offset:512 nt
  v_add_f32 v15, v15, v54
  v_add_f32 v15, v15, v55
  v_add_f32 v15, v15, v56
  v_add_f32 v15, v15, v57
  v_add_f32 v15, v15, v58
  v_add_f32 v15, v15, v59
  v_mul_f32 v52, v52, v60
  v_mul_f32 v53, v53, v61
  v_mul_f32 v54, v54, v62
  s_waitcnt vmcnt(5)
  buffer_load_dwordx4 v[136:139], v3, s[28:31], s76 offen offset:768 nt
  v_mul_f32 v55, v55, v63
  v_mul_f32 v56, v56, v64
  v_mul_f32 v57, v57, v65
  v_mul_f32 v58, v58, v66
  v_mul_f32 v59, v59, v67
  v_cvt_pk_bf16_f32 v68, v52, v53
  v_cvt_pk_bf16_f32 v69, v54, v55
  v_cvt_pk_bf16_f32 v70, v56, v57
  v_cvt_pk_bf16_f32 v71, v58, v59
  s_waitcnt vmcnt(4)
  buffer_load_dwordx4 v[140:143], v3, s[28:31], s77 offen offset:0 nt
  s_nop 1
  v_mfma_f32_16x16x32_bf16 v[112:115], v[120:123], v[68:71], v[112:115]
  s_lshl_b32 s55, s54, 10
  v_add_u32 v10, s55, v254
  ds_read_b128 v[52:55], v10
  ds_read_b128 v[56:59], v10 offset:16
  v_add_u32 v9, s60, v4
  ds_read2_b32 v[116:117], v9 offset0:0 offset1:16
  ds_read2_b32 v[118:119], v9 offset0:32 offset1:48
  s_waitcnt vmcnt(4)
  buffer_load_dwordx4 v[144:147], v3, s[28:31], s77 offen offset:256 nt
  ds_read2_b32 v[120:121], v9 offset0:64 offset1:80
  ds_read2_b32 v[122:123], v9 offset0:96 offset1:112
  s_waitcnt vmcnt(14)
  v_cvt_f32_i32 v188, v188
  v_cvt_f32_i32 v189, v189
  v_cvt_f32_i32 v190, v190
  v_cvt_f32_i32 v191, v191
  v_cvt_f32_i32 v192, v192
  v_cvt_f32_i32 v193, v193
  s_waitcnt vmcnt(5)
  buffer_load_dwordx4 v[148:151], v3, s[28:31], s77 offen offset:512 nt
  v_cvt_f32_i32 v194, v194
  v_cvt_f32_i32 v195, v195
  v_cvt_f32_i32 v196, v196
  v_cvt_f32_i32 v197, v197
  v_cvt_f32_i32 v198, v198
  v_cvt_f32_i32 v199, v199
  v_cvt_f32_i32 v200, v200
  v_cvt_f32_i32 v201, v201
  v_cvt_f32_i32 v202, v202
  s_waitcnt vmcnt(5)
  buffer_load_dwordx4 v[152:155], v3, s[28:31], s77 offen offset:768 nt
  v_cvt_f32_i32 v203, v203
  v_cvt_f32_i32 v204, v204
  v_cvt_f32_i32 v205, v205
  v_cvt_f32_i32 v206, v206
  v_cvt_f32_i32 v207, v207
  v_cvt_f32_i32 v208, v208
  v_cvt_f32_i32 v209, v209
  v_cvt_f32_i32 v210, v210
  v_cvt_f32_i32 v211, v211
  s_waitcnt vmcnt(4)
  buffer_load_dwordx4 v[156:159], v3, s[28:31], s78 offen offset:0 nt
  v_cvt_f32_i32 v212, v212
  v_cvt_f32_i32 v213, v213
  v_cvt_f32_i32 v214, v214
  v_cvt_f32_i32 v215, v215
  v_cvt_f32_i32 v216, v216
  v_cvt_f32_i32 v217, v217
  v_cvt_f32_i32 v218, v218
  v_cvt_f32_i32 v219, v219
  v_cvt_pk_bf16_f32 v36, v188, v196
  s_waitcnt vmcnt(4)
  buffer_load_dwordx4 v[160:163], v3, s[28:31], s78 offen offset:256 nt
  v_cvt_pk_bf16_f32 v37, v204, v212
  v_cvt_pk_bf16_f32 v40, v189, v197
  v_cvt_pk_bf16_f32 v41, v205, v213
  v_cvt_pk_bf16_f32 v44, v190, v198
  v_cvt_pk_bf16_f32 v45, v206, v214
  v_cvt_pk_bf16_f32 v48, v191, v199
  v_cvt_pk_bf16_f32 v49, v207, v215
  v_cvt_pk_bf16_f32 v60, v192, v200
  v_cvt_pk_bf16_f32 v61, v208, v216
  s_waitcnt vmcnt(5)
  buffer_load_dwordx4 v[164:167], v3, s[28:31], s78 offen offset:512 nt
  v_cvt_pk_bf16_f32 v64, v193, v201
  v_cvt_pk_bf16_f32 v65, v209, v217
  v_cvt_pk_bf16_f32 v72, v194, v202
  v_cvt_pk_bf16_f32 v73, v210, v218
  v_cvt_pk_bf16_f32 v76, v195, v203
  v_cvt_pk_bf16_f32 v77, v211, v219
  s_waitcnt vmcnt(11)
  v_cvt_f32_i32 v220, v220
  v_cvt_f32_i32 v221, v221
  s_waitcnt vmcnt(5)
  buffer_load_dwordx4 v[168:171], v3, s[28:31], s78 offen offset:768 nt
  v_cvt_f32_i32 v222, v222
  v_cvt_f32_i32 v223, v223
  v_cvt_f32_i32 v224, v224
  v_cvt_f32_i32 v225, v225
  v_cvt_f32_i32 v226, v226
  v_cvt_f32_i32 v227, v227
  v_cvt_f32_i32 v228, v228
  v_cvt_f32_i32 v229, v229
  v_cvt_f32_i32 v230, v230
  s_waitcnt vmcnt(4)
  buffer_load_dwordx4 v[172:175], v3, s[28:31], s79 offen offset:0 nt
  v_cvt_f32_i32 v231, v231
  v_cvt_f32_i32 v232, v232
  v_cvt_f32_i32 v233, v233
  v_cvt_f32_i32 v234, v234
  v_cvt_f32_i32 v235, v235
  v_cvt_f32_i32 v236, v236
  v_cvt_f32_i32 v237, v237
  v_cvt_f32_i32 v238, v238
  v_cvt_f32_i32 v239, v239
  s_waitcnt vmcnt(4)
  buffer_load_dwordx4 v[176:179], v3, s[28:31], s79 offen offset:256 nt
  v_cvt_f32_i32 v240, v240
  v_cvt_f32_i32 v241, v241
  v_cvt_f32_i32 v242, v242
  v_cvt_f32_i32 v243, v243
  v_cvt_f32_i32 v244, v244
  v_cvt_f32_i32 v245, v245
  v_cvt_f32_i32 v246, v246
  v_cvt_f32_i32 v247, v247
  v_cvt_f32_i32 v248, v248
  s_waitcnt vmcnt(5)
  buffer_load_dwordx4 v[180:183], v3, s[28:31], s79 offen offset:512 nt
  v_cvt_f32_i32 v249, v249
  v_cvt_f32_i32 v250, v250
  v_cvt_f32_i32 v251, v251
  v_cvt_pk_bf16_f32 v38, v220, v228
  v_cvt_pk_bf16_f32 v39, v236, v244
  v_cvt_pk_bf16_f32 v42, v221, v229
  v_cvt_pk_bf16_f32 v43, v237, v245
  v_mfma_f32_16x16x32_bf16 v[80:83], v[36:39], v[68:71], v[80:83]
  v_cvt_pk_bf16_f32 v46, v222, v230
  s_waitcnt vmcnt(5)
  buffer_load_dwordx4 v[184:187], v3, s[28:31], s79 offen offset:768 nt
  v_cvt_pk_bf16_f32 v47, v238, v246
  v_mfma_f32_16x16x32_bf16 v[84:87], v[40:43], v[68:71], v[84:87]
  v_cvt_pk_bf16_f32 v50, v223, v231
  v_cvt_pk_bf16_f32 v51, v239, v247
  v_mfma_f32_16x16x32_bf16 v[88:91], v[44:47], v[68:71], v[88:91]
  v_cvt_pk_bf16_f32 v62, v224, v232
  v_cvt_pk_bf16_f32 v63, v240, v248
  v_mfma_f32_16x16x32_bf16 v[92:95], v[48:51], v[68:71], v[92:95]
  v_cvt_pk_bf16_f32 v66, v225, v233
  v_cvt_pk_bf16_f32 v67, v241, v249
  v_mfma_f32_16x16x32_bf16 v[96:99], v[60:63], v[68:71], v[96:99]
  v_cvt_pk_bf16_f32 v74, v226, v234
  v_cvt_pk_bf16_f32 v75, v242, v250
  v_mfma_f32_16x16x32_bf16 v[100:103], v[64:67], v[68:71], v[100:103]
  v_cvt_pk_bf16_f32 v78, v227, v235
  v_cvt_pk_bf16_f32 v79, v243, v251
  v_mfma_f32_16x16x32_bf16 v[104:107], v[72:75], v[68:71], v[104:107]
  s_nop 0
  v_mfma_f32_16x16x32_bf16 v[108:111], v[76:79], v[68:71], v[108:111]
  s_sub_u32 s53, s53, 1
  s_cmp_lg_u32 s53, 0
  s_cbranch_scc1 L_vloop
  s_lshl_b32 s52, s54, 10
  s_add_u32 s54, s54, 1
  s_and_b32 s54, s54, 7
  s_lshl_b32 s76, s54, 17
  s_add_u32 s76, s76, s51
  s_add_u32 s77, s76, 16384
  s_add_u32 s78, s76, 32768
  s_add_u32 s79, s76, 49152
  s_mul_i32 s60, s54, 5632
  s_waitcnt lgkmcnt(0)
  v_fma_f32 v52, v52, s46, v255
  v_fma_f32 v53, v53, s46, v255
  v_fma_f32 v54, v54, s46, v255
  v_fma_f32 v55, v55, s46, v255
  v_fma_f32 v56, v56, s46, v255
  v_fma_f32 v57, v57, s46, v255
  v_fma_f32 v58, v58, s46, v255
  v_fma_f32 v59, v59, s46, v255
  s_waitcnt vmcnt(4)
  buffer_load_dwordx4 v[188:191], v3, s[28:31], s76 offen offset:0 nt
  v_exp_f32 v52, v52
  v_exp_f32 v53, v53
  v_exp_f32 v54, v54
  v_exp_f32 v55, v55
  v_exp_f32 v56, v56
  v_exp_f32 v57, v57
  v_exp_f32 v58, v58
  v_exp_f32 v59, v59
  v_lshlrev_b32 v60, 16, v116
  s_waitcnt vmcnt(4)
  buffer_load_dwordx4 v[192:195], v3, s[28:31], s76 offen offset:256 nt
  v_and_b32 v61, 0xffff0000, v116
  v_lshlrev_b32 v62, 16, v117
  v_and_b32 v63, 0xffff0000, v117
  v_lshlrev_b32 v64, 16, v118
  v_and_b32 v65, 0xffff0000, v118
  v_lshlrev_b32 v66, 16, v119
  v_and_b32 v67, 0xffff0000, v119
  v_add_f32 v15, v15, v52
  v_add_f32 v15, v15, v53
  s_waitcnt vmcnt(5)
  buffer_load_dwordx4 v[196:199], v3, s[28:31], s76 offen offset:512 nt
  v_add_f32 v15, v15, v54
  v_add_f32 v15, v15, v55
  v_add_f32 v15, v15, v56
  v_add_f32 v15, v15, v57
  v_add_f32 v15, v15, v58
  v_add_f32 v15, v15, v59
  v_mul_f32 v52, v52, v60
  v_mul_f32 v53, v53, v61
  v_mul_f32 v54, v54, v62
  s_waitcnt vmcnt(5)
  buffer_load_dwordx4 v[200:203], v3, s[28:31], s76 offen offset:768 nt
  v_mul_f32 v55, v55, v63
  v_mul_f32 v56, v56, v64
  v_mul_f32 v57, v57, v65
  v_mul_f32 v58, v58, v66
  v_mul_f32 v59, v59, v67
  v_cvt_pk_bf16_f32 v68, v52, v53
  v_cvt_pk_bf16_f32 v69, v54, v55
  v_cvt_pk_bf16_f32 v70, v56, v57
  v_cvt_pk_bf16_f32 v71, v58, v59
  s_waitcnt vmcnt(4)
  buffer_load_dwordx4 v[204:207], v3, s[28:31], s77 offen offset:0 nt
  s_nop 1
  v_mfma_f32_16x16x32_bf16 v[112:115], v[120:123], v[68:71], v[112:115]
  s_lshl_b32 s55, s54, 10
  v_add_u32 v10, s55, v254
  ds_read_b128 v[52:55], v10
  ds_read_b128 v[56:59], v10 offset:16
  v_add_u32 v9, s60, v4
  ds_read2_b32 v[116:117], v9 offset0:0 offset1:16
  ds_read2_b32 v[118:119], v9 offset0:32 offset1:48
  s_waitcnt vmcnt(4)
  buffer_load_dwordx4 v[208:211], v3, s[28:31], s77 offen offset:256 nt
  ds_read2_b32 v[120:121], v9 offset0:64 offset1:80
  ds_read2_b32 v[122:123], v9 offset0:96 offset1:112
  s_waitcnt vmcnt(14)
  v_cvt_f32_i32 v124, v124
  v_cvt_f32_i32 v125, v125
  v_cvt_f32_i32 v126, v126
  v_cvt_f32_i32 v127, v127
  v_cvt_f32_i32 v128, v128
  v_cvt_f32_i32 v129, v129
  s_waitcnt vmcnt(5)
  buffer_load_dwordx4 v[212:215], v3, s[28:31], s77 offen offset:512 nt
  v_cvt_f32_i32 v130, v130
  v_cvt_f32_i32 v131, v131
  v_cvt_f32_i32 v132, v132
  v_cvt_f32_i32 v133, v133
  v_cvt_f32_i32 v134, v134
  v_cvt_f32_i32 v135, v135
  v_cvt_f32_i32 v136, v136
  v_cvt_f32_i32 v137, v137
  v_cvt_f32_i32 v138, v138
  s_waitcnt vmcnt(5)
  buffer_load_dwordx4 v[216:219], v3, s[28:31], s77 offen offset:768 nt
  v_cvt_f32_i32 v139, v139
  v_cvt_f32_i32 v140, v140
  v_cvt_f32_i32 v141, v141
  v_cvt_f32_i32 v142, v142
  v_cvt_f32_i32 v143, v143
  v_cvt_f32_i32 v144, v144
  v_cvt_f32_i32 v145, v145
  v_cvt_f32_i32 v146, v146
  v_cvt_f32_i32 v147, v147
  s_waitcnt vmcnt(4)
  buffer_load_dwordx4 v[220:223], v3, s[28:31], s78 offen offset:0 nt
  v_cvt_f32_i32 v148, v148
  v_cvt_f32_i32 v149, v149
  v_cvt_f32_i32 v150, v150
  v_cvt_f32_i32 v151, v151
  v_cvt_f32_i32 v152, v152
  v_cvt_f32_i32 v153, v153
  v_cvt_f32_i32 v154, v154
  v_cvt_f32_i32 v155, v155
  v_cvt_pk_bf16_f32 v36, v124, v132
  s_waitcnt vmcnt(4)
  buffer_load_dwordx4 v[224:227], v3, s[28:31], s78 offen offset:256 nt
  v_cvt_pk_bf16_f32 v37, v140, v148
  v_cvt_pk_bf16_f32 v40, v125, v133
  v_cvt_pk_bf16_f32 v41, v141, v149
  v_cvt_pk_bf16_f32 v44, v126, v134
  v_cvt_pk_bf16_f32 v45, v142, v150
  v_cvt_pk_bf16_f32 v48, v127, v135
  v_cvt_pk_bf16_f32 v49, v143, v151
  v_cvt_pk_bf16_f32 v60, v128, v136
  v_cvt_pk_bf16_f32 v61, v144, v152
  s_waitcnt vmcnt(5)
  buffer_load_dwordx4 v[228:231], v3, s[28:31], s78 offen offset:512 nt
  v_cvt_pk_bf16_f32 v64, v129, v137
  v_cvt_pk_bf16_f32 v65, v145, v153
  v_cvt_pk_bf16_f32 v72, v130, v138
  v_cvt_pk_bf16_f32 v73, v146, v154
  v_cvt_pk_bf16_f32 v76, v131, v139
  v_cvt_pk_bf16_f32 v77, v147, v155
  s_waitcnt vmcnt(11)
  v_cvt_f32_i32 v156, v156
  v_cvt_f32_i32 v157, v157
  s_waitcnt vmcnt(5)
  buffer_load_dwordx4 v[232:235], v3, s[28:31], s78 offen offset:768 nt
  v_cvt_f32_i32 v158, v158
  v_cvt_f32_i32 v159, v159
  v_cvt_f32_i32 v160, v160
  v_cvt_f32_i32 v161, v161
  v_cvt_f32_i32 v162, v162
  v_cvt_f32_i32 v163, v163
  v_cvt_f32_i32 v164, v164
  v_cvt_f32_i32 v165, v165
  v_cvt_f32_i32 v166, v166
  s_waitcnt vmcnt(4)
  buffer_load_dwordx4 v[236:239], v3, s[28:31], s79 offen offset:0 nt
  v_cvt_f32_i32 v167, v167
  v_cvt_f32_i32 v168, v168
  v_cvt_f32_i32 v169, v169
  v_cvt_f32_i32 v170, v170
  v_cvt_f32_i32 v171, v171
  v_cvt_f32_i32 v172, v172
  v_cvt_f32_i32 v173, v173
  v_cvt_f32_i32 v174, v174
  v_cvt_f32_i32 v175, v175
  s_waitcnt vmcnt(4)
  buffer_load_dwordx4 v[240:243], v3, s[28:31], s79 offen offset:256 nt
  v_cvt_f32_i32 v176, v176
  v_cvt_f32_i32 v177, v177
  v_cvt_f32_i32 v178, v178
  v_cvt_f32_i32 v179, v179
  v_cvt_f32_i32 v180, v180
  v_cvt_f32_i32 v181, v181
  v_cvt_f32_i32 v182, v182
  v_cvt_f32_i32 v183, v183
  v_cvt_f32_i32 v184, v184
  s_waitcnt vmcnt(5)
  buffer_load_dwordx4 v[244:247], v3, s[28:31], s79 offen offset:512 nt
  v_cvt_f32_i32 v185, v185
  v_cvt_f32_i32 v186, v186
  v_cvt_f32_i32 v187, v187
  v_cvt_pk_bf16_f32 v38, v156, v164
  v_cvt_pk_bf16_f32 v39, v172, v180
  v_cvt_pk_bf16_f32 v42, v157, v165
  v_cvt_pk_bf16_f32 v43, v173, v181
  v_mfma_f32_16x16x32_bf16 v[80:83], v[36:39], v[68:71], v[80:83]
  v_cvt_pk_bf16_f32 v46, v158, v166
  s_waitcnt vmcnt(5)
  buffer_load_dwordx4 v[248:251], v3, s[28:31], s79 offen offset:768 nt
  v_cvt_pk_bf16_f32 v47, v174, v182
  v_mfma_f32_16x16x32_bf16 v[84:87], v[40:43], v[68:71], v[84:87]
  v_cvt_pk_bf16_f32 v50, v159, v167
  v_cvt_pk_bf16_f32 v51, v175, v183
  v_mfma_f32_16x16x32_bf16 v[88:91], v[44:47], v[68:71], v[88:91]
  v_cvt_pk_bf16_f32 v62, v160, v168
  v_cvt_pk_bf16_f32 v63, v176, v184
  v_mfma_f32_16x16x32_bf16 v[92:95], v[48:51], v[68:71], v[92:95]
  v_cvt_pk_bf16_f32 v66, v161, v169
  v_cvt_pk_bf16_f32 v67, v177, v185
  v_mfma_f32_16x16x32_bf16 v[96:99], v[60:63], v[68:71], v[96:99]
  v_cvt_pk_bf16_f32 v74, v162, v170
  v_cvt_pk_bf16_f32 v75, v178, v186
  v_mfma_f32_16x16x32_bf16 v[100:103], v[64:67], v[68:71], v[100:103]
  v_cvt_pk_bf16_f32 v78, v163, v171
  v_cvt_pk_bf16_f32 v79, v179, v187
  v_mfma_f32_16x16x32_bf16 v[104:107], v[72:75], v[68:71], v[104:107]
  s_nop 0
  v_mfma_f32_16x16x32_bf16 v[108:111], v[76:79], v[68:71], v[108:111]
  s_mov_b32 s40, s22
  s_and_b32 s41, s23, 0xffff
  s_mov_b32 s42, 2097152
  s_mov_b32 s43, 0x20000
  s_mov_b32 s68, s18
  s_and_b32 s69, s19, 0xffff
  s_mov_b32 s70, 262144
  s_mov_b32 s71, 0x20000
  s_memrealtime s[64:65]
  s_lshl_b32 s72, s49, 1
  s_add_u32 s72, s72, s50
  s_lshl_b32 s72, s72, 13
  s_xor_b32 s73, s72, 0x2000
  s_lshl_b32 s61, s49, 14
  s_add_u32 s61, s61, 7168
  s_lshl_b32 s62, s50, 30
  s_or_b32 s62, s62, 0x80000000
  s_xor_b32 s63, s62, 0x40000000
  s_lshl_b32 s74, s49, 11
  v_mov_b32 v3, 0
  v_and_b32 v7, 7, v1
  v_lshlrev_b32 v2, 3, v7
  v_add_u32 v4, 4096, v5
  v_lshrrev_b32 v8, 4, v1
  v_bfe_u32 v9, v1, 3, 1
  v_lshlrev_b32 v252, 8, v7
  v_lshl_add_u32 v252, v8, 5, v252
  v_lshl_add_u32 v252, v9, 7, v252
  s_waitcnt lgkmcnt(0)
  v_fma_f32 v52, v52, s46, v255
  v_fma_f32 v53, v53, s46, v255
  v_fma_f32 v54, v54, s46, v255
  v_fma_f32 v55, v55, s46, v255
  v_fma_f32 v56, v56, s46, v255
  v_fma_f32 v57, v57, s46, v255
  v_fma_f32 v58, v58, s46, v255
  v_fma_f32 v59, v59, s46, v255
  v_exp_f32 v52, v52
  v_exp_f32 v53, v53
  v_exp_f32 v54, v54
  v_exp_f32 v55, v55
  v_exp_f32 v56, v56
  v_exp_f32 v57, v57
  v_exp_f32 v58, v58
  v_exp_f32 v59, v59
  v_lshlrev_b32 v60, 16, v116
  v_and_b32 v61, 0xffff0000, v116
  v_lshlrev_b32 v62, 16, v117
  v_and_b32 v63, 0xffff0000, v117
  v_lshlrev_b32 v64, 16, v118
  v_and_b32 v65, 0xffff0000, v118
  v_lshlrev_b32 v66, 16, v119
  v_and_b32 v67, 0xffff0000, v119
  v_add_f32 v15, v15, v52
  v_add_f32 v15, v15, v53
  v_add_f32 v15, v15, v54
  v_add_f32 v15, v15, v55
  v_add_f32 v15, v15, v56
  v_add_f32 v15, v15, v57
  v_add_f32 v15, v15, v58
  v_add_f32 v15, v15, v59
  v_mul_f32 v52, v52, v60
  v_mul_f32 v53, v53, v61
  v_mul_f32 v54, v54, v62
  v_mul_f32 v55, v55, v63
  v_mul_f32 v56, v56, v64
  v_mul_f32 v57, v57, v65
  v_mul_f32 v58, v58, v66
  v_mul_f32 v59, v59, v67
  v_cvt_pk_bf16_f32 v68, v52, v53
  v_cvt_pk_bf16_f32 v69, v54, v55
  v_cvt_pk_bf16_f32 v70, v56, v57
  v_cvt_pk_bf16_f32 v71, v58, v59
  s_nop 1
  v_mfma_f32_16x16x32_bf16 v[112:115], v[120:123], v[68:71], v[112:115]
  v_mov_b32 v6, v15
  s_nop 1
  v_permlane16_swap_b32 v6, v15
  v_add_f32 v15, v15, v6
  v_mov_b32 v6, v15
  s_nop 1
  v_permlane32_swap_b32 v6, v15
  v_add_f32 v15, v15, v6
  s_waitcnt vmcnt(8)
  v_cvt_f32_i32 v188, v188
  v_cvt_f32_i32 v189, v189
  v_cvt_f32_i32 v190, v190
  v_cvt_f32_i32 v191, v191
  v_cvt_f32_i32 v192, v192
  v_cvt_f32_i32 v193, v193
  v_cvt_f32_i32 v194, v194
  v_cvt_f32_i32 v195, v195
  v_cvt_f32_i32 v196, v196
  v_cvt_f32_i32 v197, v197
  v_cvt_f32_i32 v198, v198
  v_cvt_f32_i32 v199, v199
  v_cvt_f32_i32 v200, v200
  v_cvt_f32_i32 v201, v201
  v_cvt_f32_i32 v202, v202
  v_cvt_f32_i32 v203, v203
  v_cvt_f32_i32 v204, v204
  v_cvt_f32_i32 v205, v205
  v_cvt_f32_i32 v206, v206
  v_cvt_f32_i32 v207, v207
  v_cvt_f32_i32 v208, v208
  v_cvt_f32_i32 v209, v209
  v_cvt_f32_i32 v210, v210
  v_cvt_f32_i32 v211, v211
  v_cvt_f32_i32 v212, v212
  v_cvt_f32_i32 v213, v213
  v_cvt_f32_i32 v214, v214
  v_cvt_f32_i32 v215, v215
  v_cvt_f32_i32 v216, v216
  v_cvt_f32_i32 v217, v217
  v_cvt_f32_i32 v218, v218
  v_cvt_f32_i32 v219, v219
  v_cvt_pk_bf16_f32 v36, v188, v196
  v_cvt_pk_bf16_f32 v37, v204, v212
  v_cvt_pk_bf16_f32 v40, v189, v197
  v_cvt_pk_bf16_f32 v41, v205, v213
  v_cvt_pk_bf16_f32 v44, v190, v198
  v_cvt_pk_bf16_f32 v45, v206, v214
  v_cvt_pk_bf16_f32 v48, v191, v199
  v_cvt_pk_bf16_f32 v49, v207, v215
  v_cvt_pk_bf16_f32 v60, v192, v200
  v_cvt_pk_bf16_f32 v61, v208, v216
  v_cvt_pk_bf16_f32 v64, v193, v201
  v_cvt_pk_bf16_f32 v65, v209, v217
  v_cvt_pk_bf16_f32 v72, v194, v202
  v_cvt_pk_bf16_f32 v73, v210, v218
  v_cvt_pk_bf16_f32 v76, v195, v203
  v_cvt_pk_bf16_f32 v77, v211, v219
  s_waitcnt vmcnt(0)
  v_mov_b32 v253, 1
  s_mov_b64 exec, 1
  ds_add_rtn_u32 v253, v3, v253 offset:57536
  s_mov_b64 exec, -1
  ds_read_b64 v[32:33], v3 offset:57536
  ds_read_b64 v[24:25], v2 offset:57344
  ds_read_b64 v[26:27], v2 offset:57408
  ds_read_b64 v[28:29], v2 offset:57472
  ds_read_b128 v[124:127], v5 offset:45056
  ds_read_b128 v[128:131], v5 offset:46080
  ds_read_b128 v[132:135], v5 offset:47104
  ds_read_b128 v[136:139], v5 offset:48128
  ds_read_b128 v[140:143], v5 offset:49152
  ds_read_b128 v[144:147], v5 offset:50176
  ds_read_b128 v[148:151], v5 offset:51200
  ds_read_b128 v[152:155], v5 offset:52224
  ds_read_b128 v[156:159], v5 offset:53248
  ds_read_b128 v[160:163], v5 offset:54272
  ds_read_b128 v[164:167], v5 offset:55296
  ds_read_b128 v[168:171], v5 offset:56320
  v_cvt_f32_i32 v220, v220
  v_cvt_f32_i32 v221, v221
  v_cvt_f32_i32 v222, v222
  v_cvt_f32_i32 v223, v223
  v_cvt_f32_i32 v224, v224
  v_cvt_f32_i32 v225, v225
  v_cvt_f32_i32 v226, v226
  v_cvt_f32_i32 v227, v227
  v_cvt_f32_i32 v228, v228
  v_cvt_f32_i32 v229, v229
  v_cvt_f32_i32 v230, v230
  v_cvt_f32_i32 v231, v231
  v_cvt_f32_i32 v232, v232
  v_cvt_f32_i32 v233, v233
  v_cvt_f32_i32 v234, v234
  v_cvt_f32_i32 v235, v235
  v_cvt_f32_i32 v236, v236
  v_cvt_f32_i32 v237, v237
  v_cvt_f32_i32 v238, v238
  v_cvt_f32_i32 v239, v239
  v_cvt_f32_i32 v240, v240
  v_cvt_f32_i32 v241, v241
  v_cvt_f32_i32 v242, v242
  v_cvt_f32_i32 v243, v243
  v_cvt_f32_i32 v244, v244
  v_cvt_f32_i32 v245, v245
  v_cvt_f32_i32 v246, v246
  v_cvt_f32_i32 v247, v247
  v_cvt_f32_i32 v248, v248
  v_cvt_f32_i32 v249, v249
  v_cvt_f32_i32 v250, v250
  v_cvt_f32_i32 v251, v251
  v_cvt_pk_bf16_f32 v38, v220, v228
  v_cvt_pk_bf16_f32 v39, v236, v244
  v_cvt_pk_bf16_f32 v42, v221, v229
  v_cvt_pk_bf16_f32 v43, v237, v245
  v_mfma_f32_16x16x32_bf16 v[80:83], v[36:39], v[68:71], v[80:83]
  v_cvt_pk_bf16_f32 v46, v222, v230
  v_cvt_pk_bf16_f32 v47, v238, v246
  v_mfma_f32_16x16x32_bf16 v[84:87], v[40:43], v[68:71], v[84:87]
  v_cvt_pk_bf16_f32 v50, v223, v231
  v_cvt_pk_bf16_f32 v51, v239, v247
  v_mfma_f32_16x16x32_bf16 v[88:91], v[44:47], v[68:71], v[88:91]
  v_cvt_pk_bf16_f32 v62, v224, v232
  v_cvt_pk_bf16_f32 v63, v240, v248
  v_mfma_f32_16x16x32_bf16 v[92:95], v[48:51], v[68:71], v[92:95]
  v_cvt_pk_bf16_f32 v66, v225, v233
  v_cvt_pk_bf16_f32 v67, v241, v249
  v_mfma_f32_16x16x32_bf16 v[96:99], v[60:63], v[68:71], v[96:99]
  v_cvt_pk_bf16_f32 v74, v226, v234
  v_cvt_pk_bf16_f32 v75, v242, v250
  v_mfma_f32_16x16x32_bf16 v[100:103], v[64:67], v[68:71], v[100:103]
  v_cvt_pk_bf16_f32 v78, v227, v235
  v_cvt_pk_bf16_f32 v79, v243, v251
  v_mfma_f32_16x16x32_bf16 v[104:107], v[72:75], v[68:71], v[104:107]
  s_nop 0
  v_mfma_f32_16x16x32_bf16 v[108:111], v[76:79], v[68:71], v[108:111]
  s_waitcnt lgkmcnt(0)
  v_readfirstlane_b32 s55, v253
  s_nop 7
  s_not_b64 exec, s[44:45]
  v_mov_b32 v80, v96
  v_mov_b32 v81, v97
  v_mov_b32 v82, v98
  v_mov_b32 v83, v99
  v_mov_b32 v84, v100
  v_mov_b32 v85, v101
  v_mov_b32 v86, v102
  v_mov_b32 v87, v103
  v_mov_b32 v88, v104
  v_mov_b32 v89, v105
  v_mov_b32 v90, v106
  v_mov_b32 v91, v107
  v_mov_b32 v92, v108
  v_mov_b32 v93, v109
  v_mov_b32 v94, v110
  v_mov_b32 v95, v111
  s_mov_b64 exec, -1
  s_cmp_eq_u32 s55, 3
  s_cbranch_scc1 L_last
  v_sub_f32 v80, v80, v112
  v_sub_f32 v81, v81, v113
  v_sub_f32 v82, v82, v114
  v_sub_f32 v83, v83, v115
  v_sub_f32 v84, v84, v112
  v_sub_f32 v85, v85, v113
  v_sub_f32 v86, v86, v114
  v_sub_f32 v87, v87, v115
  v_sub_f32 v88, v88, v112
  v_sub_f32 v89, v89, v113
  v_sub_f32 v90, v90, v114
  v_sub_f32 v91, v91, v115
  v_sub_f32 v92, v92, v112
  v_sub_f32 v93, v93, v113
  v_sub_f32 v94, v94, v114
  v_sub_f32 v95, v95, v115
  s_lshl_b32 s56, s55, 12
  v_add_u32 v6, s56, v5
  s_lshl_b32 s56, s55, 6
  v_add_u32 v7, s56, v2
  v_mov_b32 v8, 1
  ds_write_b128 v6, v[80:83] offset:45056
  ds_write_b128 v6, v[84:87] offset:46080
  ds_write_b128 v6, v[88:91] offset:47104
  ds_write_b128 v6, v[92:95] offset:48128
  ds_write_b64 v7, v[14:15] offset:57344
  s_waitcnt lgkmcnt(0)
  s_mov_b64 exec, 1
  ds_add_u32 v3, v8 offset:57540
  s_branch L_exit
L_last:
  v_readfirstlane_b32 s56, v33
  s_or_b32 s58, s65, s62
  v_mov_b32 v6, s64
  v_mov_b32 v7, s58
  s_mov_b64 exec, 1
  buffer_atomic_swap_x2 v[6:7], v3, s[40:43], s61 offen sc0 sc1
  s_mov_b64 exec, -1
  buffer_load_dwordx4 v[188:191], v5, s[40:43], s73 offen offset:0 sc0 sc1
  buffer_load_dwordx4 v[192:195], v5, s[40:43], s73 offen offset:1024 sc0 sc1
  buffer_load_dwordx4 v[196:199], v5, s[40:43], s73 offen offset:2048 sc0 sc1
  buffer_load_dwordx4 v[200:203], v5, s[40:43], s73 offen offset:3072 sc0 sc1
  buffer_load_dwordx4 v[204:207], v4, s[40:43], s73 offen offset:0 sc0 sc1
  buffer_load_dwordx4 v[208:211], v4, s[40:43], s73 offen offset:1024 sc0 sc1
  s_cmp_eq_u32 s56, 3
  s_cbranch_scc1 L_have3
L_respin:
  ds_read_b32 v8, v3 offset:57540
  s_waitcnt lgkmcnt(0)
  v_readfirstlane_b32 s56, v8
  s_cmp_eq_u32 s56, 3
  s_cbranch_scc0 L_respin
  ds_read_b64 v[32:33], v3 offset:57536
  ds_read_b64 v[24:25], v2 offset:57344
  ds_read_b64 v[26:27], v2 offset:57408
  ds_read_b64 v[28:29], v2 offset:57472
  ds_read_b128 v[124:127], v5 offset:45056
  ds_read_b128 v[128:131], v5 offset:46080
  ds_read_b128 v[132:135], v5 offset:47104
  ds_read_b128 v[136:139], v5 offset:48128
  ds_read_b128 v[140:143], v5 offset:49152
  ds_read_b128 v[144:147], v5 offset:50176
  ds_read_b128 v[148:151], v5 offset:51200
  ds_read_b128 v[152:155], v5 offset:52224
  ds_read_b128 v[156:159], v5 offset:53248
  ds_read_b128 v[160:163], v5 offset:54272
  ds_read_b128 v[164:167], v5 offset:55296
  ds_read_b128 v[168:171], v5 offset:56320
  s_waitcnt lgkmcnt(0)
L_have3:
  v_max_f32 v21, v14, v24
  v_max_f32 v21, v21, v26
  v_max_f32 v21, v21, v28
  v_sub_f32 v52, v14, v21
  v_sub_f32 v53, v24, v21
  v_sub_f32 v54, v26, v21
  v_sub_f32 v55, v28, v21
  v_mul_f32 v52, s46, v52
  v_mul_f32 v53, s46, v53
  v_mul_f32 v54, s46, v54
  v_mul_f32 v55, s46, v55
  v_exp_f32 v52, v52
  v_exp_f32 v53, v53
  v_exp_f32 v54, v54
  v_exp_f32 v55, v55
  s_nop 0
  v_mul_f32 v22, v52, v15
  v_fmac_f32 v22, v53, v25
  v_fmac_f32 v22, v54, v27
  v_fmac_f32 v22, v55, v29
  v_mul_f32 v60, v52, v112
  v_mul_f32 v61, v52, v113
  v_mul_f32 v62, v52, v114
  v_mul_f32 v63, v52, v115
  v_fma_f32 v80, v52, v80, -v60
  v_fma_f32 v81, v52, v81, -v61
  v_fma_f32 v82, v52, v82, -v62
  v_fma_f32 v83, v52, v83, -v63
  v_fma_f32 v84, v52, v84, -v60
  v_fma_f32 v85, v52, v85, -v61
  v_fma_f32 v86, v52, v86, -v62
  v_fma_f32 v87, v52, v87, -v63
  v_fma_f32 v88, v52, v88, -v60
  v_fma_f32 v89, v52, v89, -v61
  v_fma_f32 v90, v52, v90, -v62
  v_fma_f32 v91, v52, v91, -v63
  v_fma_f32 v92, v52, v92, -v60
  v_fma_f32 v93, v52, v93, -v61
  v_fma_f32 v94, v52, v94, -v62
  v_fma_f32 v95, v52, v95, -v63
  v_fmac_f32 v80, v53, v124
  v_fmac_f32 v81, v53, v125
  v_fmac_f32 v82, v53, v126
  v_fmac_f32 v83, v53, v127
  v_fmac_f32 v84, v53, v128
  v_fmac_f32 v85, v53, v129
  v_fmac_f32 v86, v53, v130
  v_fmac_f32 v87, v53, v131
  v_fmac_f32 v88, v53, v132
  v_fmac_f32 v89, v53, v133
  v_fmac_f32 v90, v53, v134
  v_fmac_f32 v91, v53, v135
  v_fmac_f32 v92, v53, v136
  v_fmac_f32 v93, v53, v137
  v_fmac_f32 v94, v53, v138
  v_fmac_f32 v95, v53, v139
  v_fmac_f32 v80, v54, v140
  v_fmac_f32 v81, v54, v141
  v_fmac_f32 v82, v54, v142
  v_fmac_f32 v83, v54, v143
  v_fmac_f32 v84, v54, v144
  v_fmac_f32 v85, v54, v145
  v_fmac_f32 v86, v54, v146
  v_fmac_f32 v87, v54, v147
  v_fmac_f32 v88, v54, v148
  v_fmac_f32 v89, v54, v149
  v_fmac_f32 v90, v54, v150
  v_fmac_f32 v91, v54, v151
  v_fmac_f32 v92, v54, v152
  v_fmac_f32 v93, v54, v153
  v_fmac_f32 v94, v54, v154
  v_fmac_f32 v95, v54, v155
  v_fma_f32 v172, v55, v156, v80
  v_fma_f32 v173, v55, v157, v81
  v_fma_f32 v174, v55, v158, v82
  v_fma_f32 v176, v55, v159, v83
  v_fma_f32 v177, v55, v160, v84
  v_fma_f32 v178, v55, v161, v85
  v_fma_f32 v180, v55, v162, v86
  v_fma_f32 v181, v55, v163, v87
  v_fma_f32 v182, v55, v164, v88
  v_fma_f32 v184, v55, v165, v89
  v_fma_f32 v185, v55, v166, v90
  v_fma_f32 v186, v55, v167, v91
  v_fma_f32 v16, v55, v168, v92
  v_fma_f32 v17, v55, v169, v93
  v_fma_f32 v18, v55, v170, v94
  v_fma_f32 v20, v55, v171, v95
  v_mov_b32 v175, s64
  v_mov_b32 v179, s64
  v_mov_b32 v183, s64
  v_mov_b32 v187, s64
  v_mov_b32 v19, s64
  v_mov_b32 v23, s64
  s_waitcnt vmcnt(6)
  v_readfirstlane_b32 s55, v6
  v_readfirstlane_b32 s59, v7
  s_xor_b32 s59, s59, s63
  s_sub_u32 s58, s64, s55
  s_subb_u32 s59, s65, s59
  s_add_u32 s58, s58, 0x1000000
  s_addc_u32 s59, s59, 0
  s_lshr_b32 s58, s58, 27
  s_or_b32 s58, s58, s59
  s_cbranch_scc0 L_second
  buffer_store_dwordx4 v[172:175], v5, s[40:43], s72 offen offset:0 sc0 sc1
  buffer_store_dwordx4 v[176:179], v5, s[40:43], s72 offen offset:1024 sc0 sc1
  buffer_store_dwordx4 v[180:183], v5, s[40:43], s72 offen offset:2048 sc0 sc1
  buffer_store_dwordx4 v[184:187], v5, s[40:43], s72 offen offset:3072 sc0 sc1
  buffer_store_dwordx4 v[16:19], v4, s[40:43], s72 offen offset:0 sc0 sc1
  buffer_store_dwordx4 v[20:23], v4, s[40:43], s72 offen offset:1024 sc0 sc1
  s_branch L_exit
L_second:
  v_mov_b32 v8, s55
  v_mov_b32 v6, 0
  v_mov_b32 v7, 0
  s_mov_b64 exec, 1
  buffer_store_dwordx2 v[6:7], v3, s[40:43], s61 offen sc0 sc1
  s_mov_b64 exec, -1
  s_waitcnt vmcnt(1)
L_retag:
  v_cmp_ne_u32 vcc, v8, v191
  s_or_b64 s[58:59], vcc, vcc
  v_cmp_ne_u32 vcc, v8, v195
  s_or_b64 s[58:59], vcc, s[58:59]
  v_cmp_ne_u32 vcc, v8, v199
  s_or_b64 s[58:59], vcc, s[58:59]
  v_cmp_ne_u32 vcc, v8, v203
  s_or_b64 s[58:59], vcc, s[58:59]
  v_cmp_ne_u32 vcc, v8, v207
  s_or_b64 s[58:59], vcc, s[58:59]
  v_cmp_ne_u32 vcc, v8, v211
  s_or_b64 s[58:59], vcc, s[58:59]
  s_cbranch_scc0 L_merge
  buffer_load_dwordx4 v[188:191], v5, s[40:43], s73 offen offset:0 sc0 sc1
  buffer_load_dwordx4 v[192:195], v5, s[40:43], s73 offen offset:1024 sc0 sc1
  buffer_load_dwordx4 v[196:199], v5, s[40:43], s73 offen offset:2048 sc0 sc1
  buffer_load_dwordx4 v[200:203], v5, s[40:43], s73 offen offset:3072 sc0 sc1
  buffer_load_dwordx4 v[204:207], v4, s[40:43], s73 offen offset:0 sc0 sc1
  buffer_load_dwordx4 v[208:211], v4, s[40:43], s73 offen offset:1024 sc0 sc1
  s_waitcnt vmcnt(0)
  s_branch L_retag
L_merge:
  v_max_f32 v54, v21, v209
  v_sub_f32 v52, v21, v54
  v_sub_f32 v53, v209, v54
  v_mul_f32 v52, s46, v52
  v_mul_f32 v53, s46, v53
  v_exp_f32 v52, v52
  v_exp_f32 v53, v53
  s_nop 0
  v_mul_f32 v22, v52, v22
  v_fmac_f32 v22, v53, v210
  v_rcp_f32 v22, v22
  s_nop 0
  v_mul_f32 v52, v52, v22
  v_mul_f32 v53, v53, v22
  v_mul_f32 v80, v52, v172
  v_mul_f32 v81, v52, v173
  v_mul_f32 v82, v52, v174
  v_mul_f32 v83, v52, v176
  v_mul_f32 v84, v52, v177
  v_mul_f32 v85, v52, v178
  v_mul_f32 v86, v52, v180
  v_mul_f32 v87, v52, v181
  v_mul_f32 v88, v52, v182
  v_mul_f32 v89, v52, v184
  v_mul_f32 v90, v52, v185
  v_mul_f32 v91, v52, v186
  v_mul_f32 v92, v52, v16
  v_mul_f32 v93, v52, v17
  v_mul_f32 v94, v52, v18
  v_mul_f32 v95, v52, v20
  v_fmac_f32 v80, v53, v188
  v_fmac_f32 v81, v53, v189
  v_fmac_f32 v82, v53, v190
  v_fmac_f32 v83, v53, v192
  v_fmac_f32 v84, v53, v193
  v_fmac_f32 v85, v53, v194
  v_fmac_f32 v86, v53, v196
  v_fmac_f32 v87, v53, v197
  v_fmac_f32 v88, v53, v198
  v_fmac_f32 v89, v53, v200
  v_fmac_f32 v90, v53, v201
  v_fmac_f32 v91, v53, v202
  v_fmac_f32 v92, v53, v204
  v_fmac_f32 v93, v53, v205
  v_fmac_f32 v94, v53, v206
  v_fmac_f32 v95, v53, v208
  v_cvt_pk_bf16_f32 v24, v80, v84
  v_cvt_pk_bf16_f32 v25, v88, v92
  v_cvt_pk_bf16_f32 v26, v81, v85
  v_cvt_pk_bf16_f32 v27, v89, v93
  v_cvt_pk_bf16_f32 v28, v82, v86
  v_cvt_pk_bf16_f32 v29, v90, v94
  v_cvt_pk_bf16_f32 v30, v83, v87
  v_cvt_pk_bf16_f32 v31, v91, v95
  buffer_store_dwordx4 v[24:27], v252, s[68:71], s74 offen offset:0
  buffer_store_dwordx4 v[28:31], v252, s[68:71], s74 offen offset:16
L_exit:
L_end:
  s_endpgm
.section .rodata,"a"
.p2align 6
.amdhsa_kernel standalone__kv_cache_quant_int4_int2_kv_with_per_channel_or_per_token_scales__sampling_kernel
  .amdhsa_next_free_vgpr 256
  .amdhsa_next_free_sgpr 80
  .amdhsa_accum_offset 256
  .amdhsa_group_segment_fixed_size 0
  .amdhsa_kernarg_size 80
  .amdhsa_user_sgpr_count 2
  .amdhsa_user_sgpr_kernarg_segment_ptr 1
  .amdhsa_system_sgpr_workgroup_id_x 1
  .amdhsa_float_denorm_mode_32 3
.end_amdhsa_kernel
```
